```python
import torch

def _softmax(x, axis=-1):
    return torch.softmax(x, dim=axis)
def _gelu(x):
    return torch.nn.functional.gelu(x, approximate="tanh")
def _silu(x):
    return torch.nn.functional.silu(x)
def _sigmoid(x):
    return torch.sigmoid(x)
def _layernorm(x, axis=-1, eps=1e-5):
    m = x.mean(dim=axis, keepdim=True)
    v = x.var(dim=axis, keepdim=True, unbiased=False)
    return (x - m) / torch.sqrt(v + eps)
def _scatter_add(tgt, idx, src, axis=0):
    return tgt.clone().index_add_(axis, idx, src)
def _segment_sum(src, seg, n):
    out = torch.zeros((n,) + src.shape[1:], dtype=src.dtype)
    return out.index_add_(0, seg, src)
def _pad(x, pw):
    flat = tuple(v for pair in reversed(pw) for v in pair)
    return torch.nn.functional.pad(x, flat)

kernel_name = 'sequential_preLN__mha_block__dense_activation_gelu__prompt'

def setup_inputs():

    _w = (lambda a: (lambda t: t.to(torch.bfloat16) if t.is_floating_point() else t)(torch.as_tensor(a)))
    def _A_setup():
        B, S, D, H = 1, 2048, 512, 32
        return {
            "x": _w((lambda *s: torch.randn(*s, dtype=torch.bfloat16) * 0.05)(B, S, D)),
            "wqkv": _w((lambda *s: torch.randn(*s, dtype=torch.bfloat16) * 0.05)(D, 3 * D)),
            "wo": _w((lambda *s: torch.randn(*s, dtype=torch.bfloat16) * 0.05)(D, D)),
        }
    _A_in = _A_setup()

    def _B_setup():
        B, S, D, F = 1, 2048, 512, 1792
        return {
            "x": _w((lambda *s: torch.randn(*s, dtype=torch.bfloat16) * 0.05)(B, S, D)),
            "w1": _w((lambda *s: torch.randn(*s, dtype=torch.bfloat16) * 0.8)(D, F) * (D ** -0.5)),
            "b1": _w((lambda *s: torch.randn(*s, dtype=torch.bfloat16) * 0.2)(F) * 0.01),
            "w2": _w((lambda *s: torch.randn(*s, dtype=torch.bfloat16) * 0.2)(F, D) * (F ** -0.5)),
            "b2": _w((lambda *s: torch.randn(*s, dtype=torch.bfloat16) * 0.2)(D) * 0.01),
        }
    _B_in = _B_setup()

    return {
        "A_x": _A_in["x"],
        "A_wqkv": _A_in["wqkv"],
        "A_wo": _A_in["wo"],
        "B_x": _B_in["x"],
        "B_w1": _B_in["w1"],
        "B_b1": _B_in["b1"],
        "B_w2": _B_in["w2"],
        "B_b2": _B_in["b2"],
    }

def reference(A_x, A_wqkv, A_wo, B_x, B_w1, B_b1, B_w2, B_b2):
    def _A_ref(x, wqkv, wo):
        B, S, D = x.shape
        H = 32
        Dh = D // H
        qkv = (lambda x, *d: x.permute(*d))((x @ wqkv).reshape(B, S, 3, H, Dh), 2, 0, 3, 1, 4)
        q, k, v = qkv[0], qkv[1], qkv[2]
        scores = torch.einsum("bhqd,bhkd->bhqk", q, k) * (Dh ** -0.5)
        p = _softmax(scores, axis=-1)
        o = torch.einsum("bhqk,bhkd->bhqd", p, v)
        return (lambda x, *d: x.permute(*d))(o, 0, 2, 1, 3).reshape(B, S, D) @ wo

    def _B_ref(x, w1, b1, w2, b2):
        h = torch.einsum("bsd,df->bsf", x, w1) + b1
        h = _gelu(h)
        return torch.einsum("bsf,fd->bsd", h, w2) + b2

    x = A_x
    h = x + _A_ref(_layernorm(x, axis=-1), A_wqkv, A_wo)
    h2 = h + _B_ref(_layernorm(h, axis=-1), B_w1, B_b1, B_w2, B_b2)
    return h2
```

```asm
; @launch kernel=qkv_kernel grid=(256,1,1) block=(768,1,1) lds=155648
; @launch kernel=attn_kernel grid=(256,1,1) block=(1024,1,1) lds=160000
; @launch kernel=mid_kernel grid=(256,1,1) block=(512,1,1) lds=163840
.amdgcn_target "amdgcn-amd-amdhsa--gfx950"
.text
.globl qkv_kernel
.p2align 8
.type qkv_kernel,@function
qkv_kernel:
    s_cmp_ge_u32 s2, 256
    s_cbranch_scc1 L_k1_end
    s_load_dwordx4 s[4:7], s[0:1], 0
    s_load_dwordx2 s[20:21], s[0:1], 80

    v_and_b32 v1, 63, v0
    v_lshrrev_b32 v2, 6, v0
    s_and_b32 s24, s2, 7
    s_lshr_b32 s25, s2, 3
    v_readfirstlane_b32 s26, v2

    s_lshr_b32 s27, s24, 1
    s_lshl_b32 s27, s27, 3
    s_and_b32 s28, s25, 7
    s_add_u32 s27, s27, s28
    s_and_b32 s28, s24, 1
    s_lshl_b32 s28, s28, 2
    s_lshr_b32 s29, s25, 3
    s_add_u32 s28, s28, s29
    s_and_b32 s29, s26, 3
    v_lshlrev_b32 v2, 4, v1
    s_cmp_ge_u32 s26, 8
    s_cbranch_scc1 L_k1_comp
    v_lshrrev_b32 v3, 3, v1
    v_and_b32 v4, 7, v1
    v_lshrrev_b32 v9, 4, v1
    s_lshl_b32 s31, s29, 11

    s_cmp_lt_u32 s26, 4
    s_cbranch_scc1 L_k1_ln
    v_and_b32 v5, 1, v9
    v_lshlrev_b32 v5, 2, v5
    v_xor_b32 v5, v5, v4
    v_lshlrev_b32 v5, 4, v5
    v_mul_u32_u24 v8, 3072, v3
    v_add_u32 v5, v5, v8

    s_lshl_b32 s41, s28, 7
    s_mul_i32 s35, s29, 24576
    s_add_u32 s41, s41, s35
    s_lshl_b32 s31, s29, 10
    s_waitcnt lgkmcnt(0)

    s_mov_b32 s12, s6
    s_mov_b32 s13, s7
    s_mov_b32 s14, 1572864
    s_mov_b32 s15, 0x00020000
    s_add_u32 m0, s31, 0
    s_add_u32 s35, s41, 0
    buffer_load_dwordx4 v5, s[12:15], s35 offen lds
    s_add_u32 m0, s31, 4096
    s_add_u32 s35, s41, 1024
    buffer_load_dwordx4 v5, s[12:15], s35 offen lds
    s_add_u32 m0, s31, 8192
    s_add_u32 s35, s41, 2048
    buffer_load_dwordx4 v5, s[12:15], s35 offen lds
    s_add_u32 m0, s31, 12288
    s_add_u32 s35, s41, 98304
    buffer_load_dwordx4 v5, s[12:15], s35 offen lds
    s_add_u32 m0, s31, 16384
    s_add_u32 s35, s41, 99328
    buffer_load_dwordx4 v5, s[12:15], s35 offen lds
    s_add_u32 m0, s31, 20480
    s_add_u32 s35, s41, 100352
    buffer_load_dwordx4 v5, s[12:15], s35 offen lds
    s_add_u32 m0, s31, 24576
    s_add_u32 s35, s41, 196608
    buffer_load_dwordx4 v5, s[12:15], s35 offen lds
    s_add_u32 m0, s31, 28672
    s_add_u32 s35, s41, 197632
    buffer_load_dwordx4 v5, s[12:15], s35 offen lds
    s_add_u32 m0, s31, 32768
    s_add_u32 s35, s41, 198656
    buffer_load_dwordx4 v5, s[12:15], s35 offen lds
    s_add_u32 m0, s31, 36864
    s_add_u32 s35, s41, 294912
    buffer_load_dwordx4 v5, s[12:15], s35 offen lds
    s_add_u32 m0, s31, 40960
    s_add_u32 s35, s41, 295936
    buffer_load_dwordx4 v5, s[12:15], s35 offen lds
    s_add_u32 m0, s31, 45056
    s_add_u32 s35, s41, 296960
    buffer_load_dwordx4 v5, s[12:15], s35 offen lds
    s_add_u32 m0, s31, 49152
    s_add_u32 s35, s41, 393216
    buffer_load_dwordx4 v5, s[12:15], s35 offen lds
    s_add_u32 m0, s31, 53248
    s_add_u32 s35, s41, 394240
    buffer_load_dwordx4 v5, s[12:15], s35 offen lds
    s_add_u32 m0, s31, 57344
    s_add_u32 s35, s41, 395264
    buffer_load_dwordx4 v5, s[12:15], s35 offen lds
    s_add_u32 m0, s31, 61440
    s_add_u32 s35, s41, 491520
    buffer_load_dwordx4 v5, s[12:15], s35 offen lds
    s_add_u32 m0, s31, 65536
    s_add_u32 s35, s41, 492544
    buffer_load_dwordx4 v5, s[12:15], s35 offen lds
    s_add_u32 m0, s31, 69632
    s_add_u32 s35, s41, 493568
    buffer_load_dwordx4 v5, s[12:15], s35 offen lds
    s_add_u32 m0, s31, 73728
    s_add_u32 s35, s41, 589824
    buffer_load_dwordx4 v5, s[12:15], s35 offen lds
    s_add_u32 m0, s31, 77824
    s_add_u32 s35, s41, 590848
    buffer_load_dwordx4 v5, s[12:15], s35 offen lds
    s_add_u32 m0, s31, 81920
    s_add_u32 s35, s41, 591872
    buffer_load_dwordx4 v5, s[12:15], s35 offen lds
    s_add_u32 m0, s31, 86016
    s_add_u32 s35, s41, 688128
    buffer_load_dwordx4 v5, s[12:15], s35 offen lds
    s_add_u32 m0, s31, 90112
    s_add_u32 s35, s41, 689152
    buffer_load_dwordx4 v5, s[12:15], s35 offen lds
    s_add_u32 m0, s31, 94208
    s_add_u32 s35, s41, 690176
    buffer_load_dwordx4 v5, s[12:15], s35 offen lds
    s_waitcnt vmcnt(21)
    s_barrier
    s_add_u32 m0, s31, 98304
    s_add_u32 s35, s41, 786432
    buffer_load_dwordx4 v5, s[12:15], s35 offen lds
    s_add_u32 m0, s31, 102400
    s_add_u32 s35, s41, 787456
    buffer_load_dwordx4 v5, s[12:15], s35 offen lds
    s_add_u32 m0, s31, 106496
    s_add_u32 s35, s41, 788480
    buffer_load_dwordx4 v5, s[12:15], s35 offen lds
    s_add_u32 m0, s31, 110592
    s_add_u32 s35, s41, 884736
    buffer_load_dwordx4 v5, s[12:15], s35 offen lds
    s_add_u32 m0, s31, 114688
    s_add_u32 s35, s41, 885760
    buffer_load_dwordx4 v5, s[12:15], s35 offen lds
    s_add_u32 m0, s31, 118784
    s_add_u32 s35, s41, 886784
    buffer_load_dwordx4 v5, s[12:15], s35 offen lds
    s_waitcnt vmcnt(24)
    s_barrier
    s_waitcnt vmcnt(21)
    s_barrier
    s_add_u32 m0, s31, 0
    s_add_u32 s35, s41, 983040
    buffer_load_dwordx4 v5, s[12:15], s35 offen lds
    s_add_u32 m0, s31, 4096
    s_add_u32 s35, s41, 984064
    buffer_load_dwordx4 v5, s[12:15], s35 offen lds
    s_add_u32 m0, s31, 8192
    s_add_u32 s35, s41, 985088
    buffer_load_dwordx4 v5, s[12:15], s35 offen lds
    s_waitcnt vmcnt(21)
    s_barrier
    s_add_u32 m0, s31, 12288
    s_add_u32 s35, s41, 1081344
    buffer_load_dwordx4 v5, s[12:15], s35 offen lds
    s_add_u32 m0, s31, 16384
    s_add_u32 s35, s41, 1082368
    buffer_load_dwordx4 v5, s[12:15], s35 offen lds
    s_add_u32 m0, s31, 20480
    s_add_u32 s35, s41, 1083392
    buffer_load_dwordx4 v5, s[12:15], s35 offen lds
    s_waitcnt vmcnt(21)
    s_barrier
    s_add_u32 m0, s31, 24576
    s_add_u32 s35, s41, 1179648
    buffer_load_dwordx4 v5, s[12:15], s35 offen lds
    s_add_u32 m0, s31, 28672
    s_add_u32 s35, s41, 1180672
    buffer_load_dwordx4 v5, s[12:15], s35 offen lds
    s_add_u32 m0, s31, 32768
    s_add_u32 s35, s41, 1181696
    buffer_load_dwordx4 v5, s[12:15], s35 offen lds
    s_waitcnt vmcnt(21)
    s_barrier
    s_add_u32 m0, s31, 36864
    s_add_u32 s35, s41, 1277952
    buffer_load_dwordx4 v5, s[12:15], s35 offen lds
    s_add_u32 m0, s31, 40960
    s_add_u32 s35, s41, 1278976
    buffer_load_dwordx4 v5, s[12:15], s35 offen lds
    s_add_u32 m0, s31, 45056
    s_add_u32 s35, s41, 1280000
    buffer_load_dwordx4 v5, s[12:15], s35 offen lds
    s_waitcnt vmcnt(21)
    s_barrier
    s_add_u32 m0, s31, 49152
    s_add_u32 s35, s41, 1376256
    buffer_load_dwordx4 v5, s[12:15], s35 offen lds
    s_add_u32 m0, s31, 53248
    s_add_u32 s35, s41, 1377280
    buffer_load_dwordx4 v5, s[12:15], s35 offen lds
    s_add_u32 m0, s31, 57344
    s_add_u32 s35, s41, 1378304
    buffer_load_dwordx4 v5, s[12:15], s35 offen lds
    s_waitcnt vmcnt(21)
    s_barrier
    s_add_u32 m0, s31, 61440
    s_add_u32 s35, s41, 1474560
    buffer_load_dwordx4 v5, s[12:15], s35 offen lds
    s_add_u32 m0, s31, 65536
    s_add_u32 s35, s41, 1475584
    buffer_load_dwordx4 v5, s[12:15], s35 offen lds
    s_add_u32 m0, s31, 69632
    s_add_u32 s35, s41, 1476608
    buffer_load_dwordx4 v5, s[12:15], s35 offen lds
    s_waitcnt vmcnt(21)
    s_barrier
    s_waitcnt vmcnt(18)
    s_barrier
    s_waitcnt vmcnt(15)
    s_barrier
    s_waitcnt vmcnt(12)
    s_barrier
    s_waitcnt vmcnt(9)
    s_barrier
    s_waitcnt vmcnt(6)
    s_barrier
    s_waitcnt vmcnt(3)
    s_barrier
    s_waitcnt vmcnt(0)
    s_barrier
    s_endpgm
L_k1_ln:
    v_lshlrev_b32 v6, 4, v4
    v_lshl_add_u32 v6, v3, 10, v6
    s_lshl_b32 s40, s27, 16
    s_lshl_b32 s35, s29, 14
    s_add_u32 s40, s40, s35
    s_add_u32 s39, s40, 8192
    s_waitcnt lgkmcnt(0)

    s_mov_b32 s8, s4
    s_mov_b32 s9, s5
    s_mov_b32 s10, 2097152
    s_mov_b32 s11, 0x00020000
    buffer_load_dwordx4 v[64:67], v6, s[8:11], s40 offen offset:0
    buffer_load_dwordx4 v[96:99], v6, s[8:11], s39 offen offset:0
    buffer_load_dwordx4 v[68:71], v6, s[8:11], s40 offen offset:128
    buffer_load_dwordx4 v[100:103], v6, s[8:11], s39 offen offset:128
    buffer_load_dwordx4 v[72:75], v6, s[8:11], s40 offen offset:256
    buffer_load_dwordx4 v[104:107], v6, s[8:11], s39 offen offset:256
    buffer_load_dwordx4 v[76:79], v6, s[8:11], s40 offen offset:384
    buffer_load_dwordx4 v[108:111], v6, s[8:11], s39 offen offset:384
    buffer_load_dwordx4 v[80:83], v6, s[8:11], s40 offen offset:512
    buffer_load_dwordx4 v[112:115], v6, s[8:11], s39 offen offset:512
    buffer_load_dwordx4 v[84:87], v6, s[8:11], s40 offen offset:640
    buffer_load_dwordx4 v[116:119], v6, s[8:11], s39 offen offset:640
    buffer_load_dwordx4 v[88:91], v6, s[8:11], s40 offen offset:768
    buffer_load_dwordx4 v[120:123], v6, s[8:11], s39 offen offset:768
    buffer_load_dwordx4 v[92:95], v6, s[8:11], s40 offen offset:896
    buffer_load_dwordx4 v[124:127], v6, s[8:11], s39 offen offset:896
    v_xor_b32 v32, v4, v9
    v_xor_b32 v33, 4, v32
    v_lshlrev_b32 v32, 4, v32
    v_lshlrev_b32 v33, 4, v33
    v_lshl_add_u32 v32, v3, 7, v32
    v_lshl_add_u32 v33, v3, 7, v33
    s_add_u32 s35, s31, 122880
    v_add_u32 v32, s35, v32
    v_add_u32 v33, s35, v33
    v_add_u32 v33, 1024, v33
    s_mov_b32 s38, 0x3f803f80

    v_mov_b32 v40, 0
    v_mov_b32 v41, 0
    v_mov_b32 v42, 0
    v_mov_b32 v43, 0
    v_mov_b32 v44, 0
    v_mov_b32 v45, 0
    v_mov_b32 v46, 0
    v_mov_b32 v47, 0
    s_waitcnt vmcnt(14)
    v_dot2_f32_bf16 v40, v64, s38, v40
    v_dot2_f32_bf16 v42, v64, v64, v42
    v_dot2_f32_bf16 v44, v96, s38, v44
    v_dot2_f32_bf16 v46, v96, v96, v46
    v_dot2_f32_bf16 v41, v65, s38, v41
    v_dot2_f32_bf16 v43, v65, v65, v43
    v_dot2_f32_bf16 v45, v97, s38, v45
    v_dot2_f32_bf16 v47, v97, v97, v47
    v_dot2_f32_bf16 v40, v66, s38, v40
    v_dot2_f32_bf16 v42, v66, v66, v42
    v_dot2_f32_bf16 v44, v98, s38, v44
    v_dot2_f32_bf16 v46, v98, v98, v46
    v_dot2_f32_bf16 v41, v67, s38, v41
    v_dot2_f32_bf16 v43, v67, v67, v43
    v_dot2_f32_bf16 v45, v99, s38, v45
    v_dot2_f32_bf16 v47, v99, v99, v47
    s_waitcnt vmcnt(12)
    v_dot2_f32_bf16 v40, v68, s38, v40
    v_dot2_f32_bf16 v42, v68, v68, v42
    v_dot2_f32_bf16 v44, v100, s38, v44
    v_dot2_f32_bf16 v46, v100, v100, v46
    v_dot2_f32_bf16 v41, v69, s38, v41
    v_dot2_f32_bf16 v43, v69, v69, v43
    v_dot2_f32_bf16 v45, v101, s38, v45
    v_dot2_f32_bf16 v47, v101, v101, v47
    v_dot2_f32_bf16 v40, v70, s38, v40
    v_dot2_f32_bf16 v42, v70, v70, v42
    v_dot2_f32_bf16 v44, v102, s38, v44
    v_dot2_f32_bf16 v46, v102, v102, v46
    v_dot2_f32_bf16 v41, v71, s38, v41
    v_dot2_f32_bf16 v43, v71, v71, v43
    v_dot2_f32_bf16 v45, v103, s38, v45
    v_dot2_f32_bf16 v47, v103, v103, v47
    s_waitcnt vmcnt(10)
    v_dot2_f32_bf16 v40, v72, s38, v40
    v_dot2_f32_bf16 v42, v72, v72, v42
    v_dot2_f32_bf16 v44, v104, s38, v44
    v_dot2_f32_bf16 v46, v104, v104, v46
    v_dot2_f32_bf16 v41, v73, s38, v41
    v_dot2_f32_bf16 v43, v73, v73, v43
    v_dot2_f32_bf16 v45, v105, s38, v45
    v_dot2_f32_bf16 v47, v105, v105, v47
    v_dot2_f32_bf16 v40, v74, s38, v40
    v_dot2_f32_bf16 v42, v74, v74, v42
    v_dot2_f32_bf16 v44, v106, s38, v44
    v_dot2_f32_bf16 v46, v106, v106, v46
    v_dot2_f32_bf16 v41, v75, s38, v41
    v_dot2_f32_bf16 v43, v75, v75, v43
    v_dot2_f32_bf16 v45, v107, s38, v45
    v_dot2_f32_bf16 v47, v107, v107, v47
    s_waitcnt vmcnt(8)
    v_dot2_f32_bf16 v40, v76, s38, v40
    v_dot2_f32_bf16 v42, v76, v76, v42
    v_dot2_f32_bf16 v44, v108, s38, v44
    v_dot2_f32_bf16 v46, v108, v108, v46
    v_dot2_f32_bf16 v41, v77, s38, v41
    v_dot2_f32_bf16 v43, v77, v77, v43
    v_dot2_f32_bf16 v45, v109, s38, v45
    v_dot2_f32_bf16 v47, v109, v109, v47
    v_dot2_f32_bf16 v40, v78, s38, v40
    v_dot2_f32_bf16 v42, v78, v78, v42
    v_dot2_f32_bf16 v44, v110, s38, v44
    v_dot2_f32_bf16 v46, v110, v110, v46
    v_dot2_f32_bf16 v41, v79, s38, v41
    v_dot2_f32_bf16 v43, v79, v79, v43
    v_dot2_f32_bf16 v45, v111, s38, v45
    v_dot2_f32_bf16 v47, v111, v111, v47
    s_waitcnt vmcnt(6)
    v_dot2_f32_bf16 v40, v80, s38, v40
    v_dot2_f32_bf16 v42, v80, v80, v42
    v_dot2_f32_bf16 v44, v112, s38, v44
    v_dot2_f32_bf16 v46, v112, v112, v46
    v_dot2_f32_bf16 v41, v81, s38, v41
    v_dot2_f32_bf16 v43, v81, v81, v43
    v_dot2_f32_bf16 v45, v113, s38, v45
    v_dot2_f32_bf16 v47, v113, v113, v47
    v_dot2_f32_bf16 v40, v82, s38, v40
    v_dot2_f32_bf16 v42, v82, v82, v42
    v_dot2_f32_bf16 v44, v114, s38, v44
    v_dot2_f32_bf16 v46, v114, v114, v46
    v_dot2_f32_bf16 v41, v83, s38, v41
    v_dot2_f32_bf16 v43, v83, v83, v43
    v_dot2_f32_bf16 v45, v115, s38, v45
    v_dot2_f32_bf16 v47, v115, v115, v47
    s_waitcnt vmcnt(4)
    v_dot2_f32_bf16 v40, v84, s38, v40
    v_dot2_f32_bf16 v42, v84, v84, v42
    v_dot2_f32_bf16 v44, v116, s38, v44
    v_dot2_f32_bf16 v46, v116, v116, v46
    v_dot2_f32_bf16 v41, v85, s38, v41
    v_dot2_f32_bf16 v43, v85, v85, v43
    v_dot2_f32_bf16 v45, v117, s38, v45
    v_dot2_f32_bf16 v47, v117, v117, v47
    v_dot2_f32_bf16 v40, v86, s38, v40
    v_dot2_f32_bf16 v42, v86, v86, v42
    v_dot2_f32_bf16 v44, v118, s38, v44
    v_dot2_f32_bf16 v46, v118, v118, v46
    v_dot2_f32_bf16 v41, v87, s38, v41
    v_dot2_f32_bf16 v43, v87, v87, v43
    v_dot2_f32_bf16 v45, v119, s38, v45
    v_dot2_f32_bf16 v47, v119, v119, v47
    s_waitcnt vmcnt(2)
    v_dot2_f32_bf16 v40, v88, s38, v40
    v_dot2_f32_bf16 v42, v88, v88, v42
    v_dot2_f32_bf16 v44, v120, s38, v44
    v_dot2_f32_bf16 v46, v120, v120, v46
    v_dot2_f32_bf16 v41, v89, s38, v41
    v_dot2_f32_bf16 v43, v89, v89, v43
    v_dot2_f32_bf16 v45, v121, s38, v45
    v_dot2_f32_bf16 v47, v121, v121, v47
    v_dot2_f32_bf16 v40, v90, s38, v40
    v_dot2_f32_bf16 v42, v90, v90, v42
    v_dot2_f32_bf16 v44, v122, s38, v44
    v_dot2_f32_bf16 v46, v122, v122, v46
    v_dot2_f32_bf16 v41, v91, s38, v41
    v_dot2_f32_bf16 v43, v91, v91, v43
    v_dot2_f32_bf16 v45, v123, s38, v45
    v_dot2_f32_bf16 v47, v123, v123, v47
    s_waitcnt vmcnt(0)
    v_dot2_f32_bf16 v40, v92, s38, v40
    v_dot2_f32_bf16 v42, v92, v92, v42
    v_dot2_f32_bf16 v44, v124, s38, v44
    v_dot2_f32_bf16 v46, v124, v124, v46
    v_dot2_f32_bf16 v41, v93, s38, v41
    v_dot2_f32_bf16 v43, v93, v93, v43
    v_dot2_f32_bf16 v45, v125, s38, v45
    v_dot2_f32_bf16 v47, v125, v125, v47
    v_dot2_f32_bf16 v40, v94, s38, v40
    v_dot2_f32_bf16 v42, v94, v94, v42
    v_dot2_f32_bf16 v44, v126, s38, v44
    v_dot2_f32_bf16 v46, v126, v126, v46
    v_dot2_f32_bf16 v41, v95, s38, v41
    v_dot2_f32_bf16 v43, v95, v95, v43
    v_dot2_f32_bf16 v45, v127, s38, v45
    v_dot2_f32_bf16 v47, v127, v127, v47
    s_nop 2
    v_add_f32 v48, v40, v41
    v_add_f32 v49, v42, v43
    v_add_f32 v50, v44, v45
    v_add_f32 v51, v46, v47
    s_nop 1
    v_add_f32_dpp v48, v48, v48 quad_perm:[1,0,3,2] row_mask:0xf bank_mask:0xf
    v_add_f32_dpp v49, v49, v49 quad_perm:[1,0,3,2] row_mask:0xf bank_mask:0xf
    v_add_f32_dpp v50, v50, v50 quad_perm:[1,0,3,2] row_mask:0xf bank_mask:0xf
    v_add_f32_dpp v51, v51, v51 quad_perm:[1,0,3,2] row_mask:0xf bank_mask:0xf
    s_nop 1
    v_add_f32_dpp v48, v48, v48 quad_perm:[2,3,0,1] row_mask:0xf bank_mask:0xf
    v_add_f32_dpp v49, v49, v49 quad_perm:[2,3,0,1] row_mask:0xf bank_mask:0xf
    v_add_f32_dpp v50, v50, v50 quad_perm:[2,3,0,1] row_mask:0xf bank_mask:0xf
    v_add_f32_dpp v51, v51, v51 quad_perm:[2,3,0,1] row_mask:0xf bank_mask:0xf
    s_nop 1
    v_add_f32_dpp v48, v48, v48 row_half_mirror row_mask:0xf bank_mask:0xf
    v_add_f32_dpp v49, v49, v49 row_half_mirror row_mask:0xf bank_mask:0xf
    v_add_f32_dpp v50, v50, v50 row_half_mirror row_mask:0xf bank_mask:0xf
    v_add_f32_dpp v51, v51, v51 row_half_mirror row_mask:0xf bank_mask:0xf
    v_mul_f32 v48, 0xbb000000, v48
    v_mul_f32 v49, 0x3b000000, v49
    v_fma_f32 v49, -v48, v48, v49
    v_max_f32 v49, 0, v49
    v_add_f32 v49, 0x3727c5ac, v49
    v_rsq_f32 v49, v49
    s_nop 0

    v_mov_b32 v56, v49
    v_mul_f32 v57, v48, v49
    v_mul_f32 v50, 0xbb000000, v50
    v_mul_f32 v51, 0x3b000000, v51
    v_fma_f32 v51, -v50, v50, v51
    v_max_f32 v51, 0, v51
    v_add_f32 v51, 0x3727c5ac, v51
    v_rsq_f32 v51, v51
    s_nop 0

    v_mov_b32 v58, v51
    v_mul_f32 v59, v50, v51
    v_lshlrev_b32 v20, 16, v64
    v_lshlrev_b32 v22, 16, v65
    v_and_b32 v21, 0xffff0000, v64
    v_and_b32 v23, 0xffff0000, v65
    v_fma_f32 v20, v20, v56, v57
    v_fma_f32 v22, v22, v56, v57
    v_fma_f32 v21, v21, v56, v57
    v_fma_f32 v23, v23, v56, v57
    v_cvt_pk_bf16_f32 v64, v20, v21
    v_cvt_pk_bf16_f32 v65, v22, v23
    v_lshlrev_b32 v20, 16, v66
    v_lshlrev_b32 v22, 16, v67
    v_and_b32 v21, 0xffff0000, v66
    v_and_b32 v23, 0xffff0000, v67
    v_fma_f32 v20, v20, v56, v57
    v_fma_f32 v22, v22, v56, v57
    v_fma_f32 v21, v21, v56, v57
    v_fma_f32 v23, v23, v56, v57
    v_cvt_pk_bf16_f32 v66, v20, v21
    v_cvt_pk_bf16_f32 v67, v22, v23
    ds_write_b128 v32, v[64:67] offset:0
    v_lshlrev_b32 v20, 16, v96
    v_lshlrev_b32 v22, 16, v97
    v_and_b32 v21, 0xffff0000, v96
    v_and_b32 v23, 0xffff0000, v97
    v_fma_f32 v20, v20, v58, v59
    v_fma_f32 v22, v22, v58, v59
    v_fma_f32 v21, v21, v58, v59
    v_fma_f32 v23, v23, v58, v59
    v_cvt_pk_bf16_f32 v96, v20, v21
    v_cvt_pk_bf16_f32 v97, v22, v23
    v_lshlrev_b32 v20, 16, v98
    v_lshlrev_b32 v22, 16, v99
    v_and_b32 v21, 0xffff0000, v98
    v_and_b32 v23, 0xffff0000, v99
    v_fma_f32 v20, v20, v58, v59
    v_fma_f32 v22, v22, v58, v59
    v_fma_f32 v21, v21, v58, v59
    v_fma_f32 v23, v23, v58, v59
    v_cvt_pk_bf16_f32 v98, v20, v21
    v_cvt_pk_bf16_f32 v99, v22, v23
    ds_write_b128 v33, v[96:99] offset:0
    v_lshlrev_b32 v20, 16, v68
    v_lshlrev_b32 v22, 16, v69
    v_and_b32 v21, 0xffff0000, v68
    v_and_b32 v23, 0xffff0000, v69
    v_fma_f32 v20, v20, v56, v57
    v_fma_f32 v22, v22, v56, v57
    v_fma_f32 v21, v21, v56, v57
    v_fma_f32 v23, v23, v56, v57
    v_cvt_pk_bf16_f32 v68, v20, v21
    v_cvt_pk_bf16_f32 v69, v22, v23
    v_lshlrev_b32 v20, 16, v70
    v_lshlrev_b32 v22, 16, v71
    v_and_b32 v21, 0xffff0000, v70
    v_and_b32 v23, 0xffff0000, v71
    v_fma_f32 v20, v20, v56, v57
    v_fma_f32 v22, v22, v56, v57
    v_fma_f32 v21, v21, v56, v57
    v_fma_f32 v23, v23, v56, v57
    v_cvt_pk_bf16_f32 v70, v20, v21
    v_cvt_pk_bf16_f32 v71, v22, v23
    ds_write_b128 v32, v[68:71] offset:8192
    s_waitcnt lgkmcnt(1)
    s_barrier
    v_lshlrev_b32 v20, 16, v100
    v_lshlrev_b32 v22, 16, v101
    v_and_b32 v21, 0xffff0000, v100
    v_and_b32 v23, 0xffff0000, v101
    v_fma_f32 v20, v20, v58, v59
    v_fma_f32 v22, v22, v58, v59
    v_fma_f32 v21, v21, v58, v59
    v_fma_f32 v23, v23, v58, v59
    v_cvt_pk_bf16_f32 v100, v20, v21
    v_cvt_pk_bf16_f32 v101, v22, v23
    v_lshlrev_b32 v20, 16, v102
    v_lshlrev_b32 v22, 16, v103
    v_and_b32 v21, 0xffff0000, v102
    v_and_b32 v23, 0xffff0000, v103
    v_fma_f32 v20, v20, v58, v59
    v_fma_f32 v22, v22, v58, v59
    v_fma_f32 v21, v21, v58, v59
    v_fma_f32 v23, v23, v58, v59
    v_cvt_pk_bf16_f32 v102, v20, v21
    v_cvt_pk_bf16_f32 v103, v22, v23
    ds_write_b128 v33, v[100:103] offset:8192
    s_waitcnt lgkmcnt(1)
    s_barrier
    v_lshlrev_b32 v20, 16, v72
    v_lshlrev_b32 v22, 16, v73
    v_and_b32 v21, 0xffff0000, v72
    v_and_b32 v23, 0xffff0000, v73
    v_fma_f32 v20, v20, v56, v57
    v_fma_f32 v22, v22, v56, v57
    v_fma_f32 v21, v21, v56, v57
    v_fma_f32 v23, v23, v56, v57
    v_cvt_pk_bf16_f32 v72, v20, v21
    v_cvt_pk_bf16_f32 v73, v22, v23
    v_lshlrev_b32 v20, 16, v74
    v_lshlrev_b32 v22, 16, v75
    v_and_b32 v21, 0xffff0000, v74
    v_and_b32 v23, 0xffff0000, v75
    v_fma_f32 v20, v20, v56, v57
    v_fma_f32 v22, v22, v56, v57
    v_fma_f32 v21, v21, v56, v57
    v_fma_f32 v23, v23, v56, v57
    v_cvt_pk_bf16_f32 v74, v20, v21
    v_cvt_pk_bf16_f32 v75, v22, v23
    ds_write_b128 v32, v[72:75] offset:16384
    s_waitcnt lgkmcnt(1)
    s_barrier
    v_lshlrev_b32 v20, 16, v104
    v_lshlrev_b32 v22, 16, v105
    v_and_b32 v21, 0xffff0000, v104
    v_and_b32 v23, 0xffff0000, v105
    v_fma_f32 v20, v20, v58, v59
    v_fma_f32 v22, v22, v58, v59
    v_fma_f32 v21, v21, v58, v59
    v_fma_f32 v23, v23, v58, v59
    v_cvt_pk_bf16_f32 v104, v20, v21
    v_cvt_pk_bf16_f32 v105, v22, v23
    v_lshlrev_b32 v20, 16, v106
    v_lshlrev_b32 v22, 16, v107
    v_and_b32 v21, 0xffff0000, v106
    v_and_b32 v23, 0xffff0000, v107
    v_fma_f32 v20, v20, v58, v59
    v_fma_f32 v22, v22, v58, v59
    v_fma_f32 v21, v21, v58, v59
    v_fma_f32 v23, v23, v58, v59
    v_cvt_pk_bf16_f32 v106, v20, v21
    v_cvt_pk_bf16_f32 v107, v22, v23
    ds_write_b128 v33, v[104:107] offset:16384
    s_waitcnt lgkmcnt(1)
    s_barrier
    v_lshlrev_b32 v20, 16, v76
    v_lshlrev_b32 v22, 16, v77
    v_and_b32 v21, 0xffff0000, v76
    v_and_b32 v23, 0xffff0000, v77
    v_fma_f32 v20, v20, v56, v57
    v_fma_f32 v22, v22, v56, v57
    v_fma_f32 v21, v21, v56, v57
    v_fma_f32 v23, v23, v56, v57
    v_cvt_pk_bf16_f32 v76, v20, v21
    v_cvt_pk_bf16_f32 v77, v22, v23
    v_lshlrev_b32 v20, 16, v78
    v_lshlrev_b32 v22, 16, v79
    v_and_b32 v21, 0xffff0000, v78
    v_and_b32 v23, 0xffff0000, v79
    v_fma_f32 v20, v20, v56, v57
    v_fma_f32 v22, v22, v56, v57
    v_fma_f32 v21, v21, v56, v57
    v_fma_f32 v23, v23, v56, v57
    v_cvt_pk_bf16_f32 v78, v20, v21
    v_cvt_pk_bf16_f32 v79, v22, v23
    ds_write_b128 v32, v[76:79] offset:24576
    s_waitcnt lgkmcnt(1)
    s_barrier
    v_lshlrev_b32 v20, 16, v108
    v_lshlrev_b32 v22, 16, v109
    v_and_b32 v21, 0xffff0000, v108
    v_and_b32 v23, 0xffff0000, v109
    v_fma_f32 v20, v20, v58, v59
    v_fma_f32 v22, v22, v58, v59
    v_fma_f32 v21, v21, v58, v59
    v_fma_f32 v23, v23, v58, v59
    v_cvt_pk_bf16_f32 v108, v20, v21
    v_cvt_pk_bf16_f32 v109, v22, v23
    v_lshlrev_b32 v20, 16, v110
    v_lshlrev_b32 v22, 16, v111
    v_and_b32 v21, 0xffff0000, v110
    v_and_b32 v23, 0xffff0000, v111
    v_fma_f32 v20, v20, v58, v59
    v_fma_f32 v22, v22, v58, v59
    v_fma_f32 v21, v21, v58, v59
    v_fma_f32 v23, v23, v58, v59
    v_cvt_pk_bf16_f32 v110, v20, v21
    v_cvt_pk_bf16_f32 v111, v22, v23
    ds_write_b128 v33, v[108:111] offset:24576
    s_waitcnt lgkmcnt(1)
    s_barrier
    v_lshlrev_b32 v20, 16, v80
    v_lshlrev_b32 v22, 16, v81
    v_and_b32 v21, 0xffff0000, v80
    v_and_b32 v23, 0xffff0000, v81
    v_fma_f32 v20, v20, v56, v57
    v_fma_f32 v22, v22, v56, v57
    v_fma_f32 v21, v21, v56, v57
    v_fma_f32 v23, v23, v56, v57
    v_cvt_pk_bf16_f32 v80, v20, v21
    v_cvt_pk_bf16_f32 v81, v22, v23
    v_lshlrev_b32 v20, 16, v82
    v_lshlrev_b32 v22, 16, v83
    v_and_b32 v21, 0xffff0000, v82
    v_and_b32 v23, 0xffff0000, v83
    v_fma_f32 v20, v20, v56, v57
    v_fma_f32 v22, v22, v56, v57
    v_fma_f32 v21, v21, v56, v57
    v_fma_f32 v23, v23, v56, v57
    v_cvt_pk_bf16_f32 v82, v20, v21
    v_cvt_pk_bf16_f32 v83, v22, v23
    ds_write_b128 v32, v[80:83] offset:0
    s_waitcnt lgkmcnt(1)
    s_barrier
    v_lshlrev_b32 v20, 16, v112
    v_lshlrev_b32 v22, 16, v113
    v_and_b32 v21, 0xffff0000, v112
    v_and_b32 v23, 0xffff0000, v113
    v_fma_f32 v20, v20, v58, v59
    v_fma_f32 v22, v22, v58, v59
    v_fma_f32 v21, v21, v58, v59
    v_fma_f32 v23, v23, v58, v59
    v_cvt_pk_bf16_f32 v112, v20, v21
    v_cvt_pk_bf16_f32 v113, v22, v23
    v_lshlrev_b32 v20, 16, v114
    v_lshlrev_b32 v22, 16, v115
    v_and_b32 v21, 0xffff0000, v114
    v_and_b32 v23, 0xffff0000, v115
    v_fma_f32 v20, v20, v58, v59
    v_fma_f32 v22, v22, v58, v59
    v_fma_f32 v21, v21, v58, v59
    v_fma_f32 v23, v23, v58, v59
    v_cvt_pk_bf16_f32 v114, v20, v21
    v_cvt_pk_bf16_f32 v115, v22, v23
    ds_write_b128 v33, v[112:115] offset:0
    s_waitcnt lgkmcnt(1)
    s_barrier
    v_lshlrev_b32 v20, 16, v84
    v_lshlrev_b32 v22, 16, v85
    v_and_b32 v21, 0xffff0000, v84
    v_and_b32 v23, 0xffff0000, v85
    v_fma_f32 v20, v20, v56, v57
    v_fma_f32 v22, v22, v56, v57
    v_fma_f32 v21, v21, v56, v57
    v_fma_f32 v23, v23, v56, v57
    v_cvt_pk_bf16_f32 v84, v20, v21
    v_cvt_pk_bf16_f32 v85, v22, v23
    v_lshlrev_b32 v20, 16, v86
    v_lshlrev_b32 v22, 16, v87
    v_and_b32 v21, 0xffff0000, v86
    v_and_b32 v23, 0xffff0000, v87
    v_fma_f32 v20, v20, v56, v57
    v_fma_f32 v22, v22, v56, v57
    v_fma_f32 v21, v21, v56, v57
    v_fma_f32 v23, v23, v56, v57
    v_cvt_pk_bf16_f32 v86, v20, v21
    v_cvt_pk_bf16_f32 v87, v22, v23
    ds_write_b128 v32, v[84:87] offset:8192
    s_waitcnt lgkmcnt(1)
    s_barrier
    v_lshlrev_b32 v20, 16, v116
    v_lshlrev_b32 v22, 16, v117
    v_and_b32 v21, 0xffff0000, v116
    v_and_b32 v23, 0xffff0000, v117
    v_fma_f32 v20, v20, v58, v59
    v_fma_f32 v22, v22, v58, v59
    v_fma_f32 v21, v21, v58, v59
    v_fma_f32 v23, v23, v58, v59
    v_cvt_pk_bf16_f32 v116, v20, v21
    v_cvt_pk_bf16_f32 v117, v22, v23
    v_lshlrev_b32 v20, 16, v118
    v_lshlrev_b32 v22, 16, v119
    v_and_b32 v21, 0xffff0000, v118
    v_and_b32 v23, 0xffff0000, v119
    v_fma_f32 v20, v20, v58, v59
    v_fma_f32 v22, v22, v58, v59
    v_fma_f32 v21, v21, v58, v59
    v_fma_f32 v23, v23, v58, v59
    v_cvt_pk_bf16_f32 v118, v20, v21
    v_cvt_pk_bf16_f32 v119, v22, v23
    ds_write_b128 v33, v[116:119] offset:8192
    s_waitcnt lgkmcnt(1)
    s_barrier
    v_lshlrev_b32 v20, 16, v88
    v_lshlrev_b32 v22, 16, v89
    v_and_b32 v21, 0xffff0000, v88
    v_and_b32 v23, 0xffff0000, v89
    v_fma_f32 v20, v20, v56, v57
    v_fma_f32 v22, v22, v56, v57
    v_fma_f32 v21, v21, v56, v57
    v_fma_f32 v23, v23, v56, v57
    v_cvt_pk_bf16_f32 v88, v20, v21
    v_cvt_pk_bf16_f32 v89, v22, v23
    v_lshlrev_b32 v20, 16, v90
    v_lshlrev_b32 v22, 16, v91
    v_and_b32 v21, 0xffff0000, v90
    v_and_b32 v23, 0xffff0000, v91
    v_fma_f32 v20, v20, v56, v57
    v_fma_f32 v22, v22, v56, v57
    v_fma_f32 v21, v21, v56, v57
    v_fma_f32 v23, v23, v56, v57
    v_cvt_pk_bf16_f32 v90, v20, v21
    v_cvt_pk_bf16_f32 v91, v22, v23
    ds_write_b128 v32, v[88:91] offset:16384
    s_waitcnt lgkmcnt(1)
    s_barrier
    v_lshlrev_b32 v20, 16, v120
    v_lshlrev_b32 v22, 16, v121
    v_and_b32 v21, 0xffff0000, v120
    v_and_b32 v23, 0xffff0000, v121
    v_fma_f32 v20, v20, v58, v59
    v_fma_f32 v22, v22, v58, v59
    v_fma_f32 v21, v21, v58, v59
    v_fma_f32 v23, v23, v58, v59
    v_cvt_pk_bf16_f32 v120, v20, v21
    v_cvt_pk_bf16_f32 v121, v22, v23
    v_lshlrev_b32 v20, 16, v122
    v_lshlrev_b32 v22, 16, v123
    v_and_b32 v21, 0xffff0000, v122
    v_and_b32 v23, 0xffff0000, v123
    v_fma_f32 v20, v20, v58, v59
    v_fma_f32 v22, v22, v58, v59
    v_fma_f32 v21, v21, v58, v59
    v_fma_f32 v23, v23, v58, v59
    v_cvt_pk_bf16_f32 v122, v20, v21
    v_cvt_pk_bf16_f32 v123, v22, v23
    ds_write_b128 v33, v[120:123] offset:16384
    s_waitcnt lgkmcnt(1)
    s_barrier
    v_lshlrev_b32 v20, 16, v92
    v_lshlrev_b32 v22, 16, v93
    v_and_b32 v21, 0xffff0000, v92
    v_and_b32 v23, 0xffff0000, v93
    v_fma_f32 v20, v20, v56, v57
    v_fma_f32 v22, v22, v56, v57
    v_fma_f32 v21, v21, v56, v57
    v_fma_f32 v23, v23, v56, v57
    v_cvt_pk_bf16_f32 v92, v20, v21
    v_cvt_pk_bf16_f32 v93, v22, v23
    v_lshlrev_b32 v20, 16, v94
    v_lshlrev_b32 v22, 16, v95
    v_and_b32 v21, 0xffff0000, v94
    v_and_b32 v23, 0xffff0000, v95
    v_fma_f32 v20, v20, v56, v57
    v_fma_f32 v22, v22, v56, v57
    v_fma_f32 v21, v21, v56, v57
    v_fma_f32 v23, v23, v56, v57
    v_cvt_pk_bf16_f32 v94, v20, v21
    v_cvt_pk_bf16_f32 v95, v22, v23
    ds_write_b128 v32, v[92:95] offset:24576
    s_waitcnt lgkmcnt(1)
    s_barrier
    v_lshlrev_b32 v20, 16, v124
    v_lshlrev_b32 v22, 16, v125
    v_and_b32 v21, 0xffff0000, v124
    v_and_b32 v23, 0xffff0000, v125
    v_fma_f32 v20, v20, v58, v59
    v_fma_f32 v22, v22, v58, v59
    v_fma_f32 v21, v21, v58, v59
    v_fma_f32 v23, v23, v58, v59
    v_cvt_pk_bf16_f32 v124, v20, v21
    v_cvt_pk_bf16_f32 v125, v22, v23
    v_lshlrev_b32 v20, 16, v126
    v_lshlrev_b32 v22, 16, v127
    v_and_b32 v21, 0xffff0000, v126
    v_and_b32 v23, 0xffff0000, v127
    v_fma_f32 v20, v20, v58, v59
    v_fma_f32 v22, v22, v58, v59
    v_fma_f32 v21, v21, v58, v59
    v_fma_f32 v23, v23, v58, v59
    v_cvt_pk_bf16_f32 v126, v20, v21
    v_cvt_pk_bf16_f32 v127, v22, v23
    ds_write_b128 v33, v[124:127] offset:24576
    s_waitcnt lgkmcnt(1)
    s_barrier
    s_waitcnt lgkmcnt(0)
    s_barrier
    s_waitcnt lgkmcnt(0)
    s_barrier
    s_endpgm
L_k1_comp:
    s_getpc_b64 s[54:55]
L_k1_pc:
    s_sub_u32 s54, s54, L_k1_pc - qkv_kernel
    s_subb_u32 s55, s55, 0
    s_lshl_b32 s35, s25, 10
    s_cmp_lg_u32 s29, 0
    s_cbranch_scc1 L_k1_nopc
    s_cmp_lt_u32 s35, (L_k2_end - qkv_kernel) & 0xfffffc00
    s_cbranch_scc0 L_k1_nopc
    v_add_u32 v4, s35, v2
    v_mov_b32 v5, s55
    v_add_co_u32 v4, vcc, s54, v4
    s_nop 1
    v_addc_co_u32 v5, vcc, 0, v5, vcc
    global_load_dwordx4 v[24:27], v[4:5], off
L_k1_nopc:
    s_mul_i32 s35, s2, 6144
    s_mul_i32 s36, s29, 1536
    s_add_u32 s35, s35, s36
    s_waitcnt lgkmcnt(0)
    s_mov_b32 s12, s6
    s_mov_b32 s13, s7
    s_mov_b32 s14, 1572864
    s_mov_b32 s15, 0x00020000
    buffer_load_dwordx4 v[24:27], v2, s[12:15], s35 offen
    buffer_load_dwordx4 v[24:27], v2, s[12:15], s35 offen offset:512
    v_and_b32 v16, 31, v1
    v_lshrrev_b32 v17, 5, v1
    v_bfe_u32 v18, v1, 1, 3
    s_and_b32 s35, s29, 1
    s_lshl_b32 s35, s35, 12
    s_add_u32 s35, s35, 122880
    s_lshr_b32 s37, s29, 1

    v_or_b32 v8, 0, v17
    v_xor_b32 v8, v8, v18
    v_lshlrev_b32 v8, 4, v8
    v_lshl_add_u32 v8, v16, 7, v8
    v_add_u32 v8, s35, v8
    v_or_b32 v9, 2, v17
    v_xor_b32 v9, v9, v18
    v_lshlrev_b32 v9, 4, v9
    v_lshl_add_u32 v9, v16, 7, v9
    v_add_u32 v9, s35, v9
    v_or_b32 v10, 4, v17
    v_xor_b32 v10, v10, v18
    v_lshlrev_b32 v10, 4, v10
    v_lshl_add_u32 v10, v16, 7, v10
    v_add_u32 v10, s35, v10
    v_or_b32 v11, 6, v17
    v_xor_b32 v11, v11, v18
    v_lshlrev_b32 v11, 4, v11
    v_lshl_add_u32 v11, v16, 7, v11
    v_add_u32 v11, s35, v11
    v_and_b32 v21, 1, v1
    v_lshlrev_b32 v21, 4, v21
    v_bfe_u32 v22, v1, 1, 1
    v_lshl_or_b32 v21, v22, 3, v21
    v_bfe_u32 v22, v1, 4, 1
    v_lshl_or_b32 v21, v22, 5, v21

    v_lshlrev_b32 v22, 3, v17
    v_bfe_u32 v23, v1, 2, 2
    v_add_u32 v22, v22, v23
    v_lshlrev_b32 v22, 7, v22
    s_lshl_b32 s36, s37, 6
    v_or_b32 v21, s36, v21
    v_lshrrev_b32 v23, 1, v23
    v_lshlrev_b32 v23, 6, v23
    v_xor_b32 v21, v21, v23
    v_add_u32 v12, v22, v21
    v_add_u32 v13, 61440, v12
    s_lshl_b32 s40, s28, 2
    s_lshl_b32 s41, s37, 1
    s_add_u32 s40, s40, s41
    s_lshl_b32 s40, s40, 16
    s_lshl_b32 s41, s27, 1
    s_and_b32 s42, s29, 1
    s_add_u32 s41, s41, s42
    s_lshl_b32 s41, s41, 10
    s_add_u32 s40, s40, s41
    s_mov_b32 s43, 0x3eb8aa3b
    v_and_b32 v3, 15, v1
    v_lshlrev_b32 v3, 4, v3
    v_lshl_or_b32 v3, v17, 8, v3
    v_bfe_u32 v4, v1, 4, 1
    v_lshl_or_b32 v3, v4, 16, v3
    s_waitcnt lgkmcnt(0)

    s_mov_b32 s16, s20
    s_mov_b32 s17, s21
    s_mov_b32 s18, 20971520
    s_mov_b32 s19, 0x00020000
    s_cmp_lg_u32 s2, 0
    s_cbranch_scc1 L_k1_nz
    s_lshl_b32 s44, s29, 10
    s_add_u32 s44, s44, 18350080
    v_mov_b32 v28, 0
    v_mov_b32 v29, 0
    v_mov_b32 v30, 0
    v_mov_b32 v31, 0
    buffer_store_dwordx4 v[28:31], v2, s[16:19], s44 offen sc0 sc1
    s_add_u32 s44, s44, 4096
    buffer_store_dwordx4 v[28:31], v2, s[16:19], s44 offen sc0 sc1
L_k1_nz:
    v_mov_b32 v80, 0
    v_mov_b32 v81, 0
    v_mov_b32 v82, 0
    v_mov_b32 v83, 0
    v_mov_b32 v84, 0
    v_mov_b32 v85, 0
    v_mov_b32 v86, 0
    v_mov_b32 v87, 0
    v_mov_b32 v88, 0
    v_mov_b32 v89, 0
    v_mov_b32 v90, 0
    v_mov_b32 v91, 0
    v_mov_b32 v92, 0
    v_mov_b32 v93, 0
    v_mov_b32 v94, 0
    v_mov_b32 v95, 0
    v_mov_b32 v96, 0
    v_mov_b32 v97, 0
    v_mov_b32 v98, 0
    v_mov_b32 v99, 0
    v_mov_b32 v100, 0
    v_mov_b32 v101, 0
    v_mov_b32 v102, 0
    v_mov_b32 v103, 0
    v_mov_b32 v104, 0
    v_mov_b32 v105, 0
    v_mov_b32 v106, 0
    v_mov_b32 v107, 0
    v_mov_b32 v108, 0
    v_mov_b32 v109, 0
    v_mov_b32 v110, 0
    v_mov_b32 v111, 0
    v_mov_b32 v112, 0
    v_mov_b32 v113, 0
    v_mov_b32 v114, 0
    v_mov_b32 v115, 0
    v_mov_b32 v116, 0
    v_mov_b32 v117, 0
    v_mov_b32 v118, 0
    v_mov_b32 v119, 0
    v_mov_b32 v120, 0
    v_mov_b32 v121, 0
    v_mov_b32 v122, 0
    v_mov_b32 v123, 0
    v_mov_b32 v124, 0
    v_mov_b32 v125, 0
    v_mov_b32 v126, 0
    v_mov_b32 v127, 0
    s_barrier
    ds_read_b128 v[32:35], v8 offset:0
    ds_read_b64_tr_b16 v[36:37], v12 offset:0
    ds_read_b64_tr_b16 v[38:39], v12 offset:512
    ds_read_b64_tr_b16 v[40:41], v12 offset:4096
    ds_read_b64_tr_b16 v[42:43], v12 offset:4608
    ds_read_b64_tr_b16 v[44:45], v12 offset:8192
    ds_read_b64_tr_b16 v[46:47], v12 offset:8704
    ds_read_b128 v[48:51], v9 offset:0
    ds_read_b64_tr_b16 v[52:53], v12 offset:2048
    ds_read_b64_tr_b16 v[54:55], v12 offset:2560
    ds_read_b64_tr_b16 v[56:57], v12 offset:6144
    ds_read_b64_tr_b16 v[58:59], v12 offset:6656
    s_waitcnt lgkmcnt(5)
    v_mfma_f32_32x32x16_bf16 v[80:95], v[36:39], v[32:35], v[80:95]
    ds_read_b64_tr_b16 v[60:61], v12 offset:10240
    ds_read_b64_tr_b16 v[62:63], v12 offset:10752
    v_mfma_f32_32x32x16_bf16 v[96:111], v[40:43], v[32:35], v[96:111]
    s_barrier
    ds_read_b128 v[64:67], v10 offset:0
    ds_read_b64_tr_b16 v[68:69], v12 offset:12288
    ds_read_b64_tr_b16 v[70:71], v12 offset:12800
    v_mfma_f32_32x32x16_bf16 v[112:127], v[32:35], v[44:47], v[112:127]
    ds_read_b64_tr_b16 v[72:73], v12 offset:16384
    ds_read_b64_tr_b16 v[74:75], v12 offset:16896
    s_waitcnt lgkmcnt(5)
    v_mfma_f32_32x32x16_bf16 v[80:95], v[52:55], v[48:51], v[80:95]
    ds_read_b64_tr_b16 v[76:77], v12 offset:20480
    ds_read_b64_tr_b16 v[78:79], v12 offset:20992
    v_mfma_f32_32x32x16_bf16 v[96:111], v[56:59], v[48:51], v[96:111]
    ds_read_b128 v[32:35], v11 offset:0
    ds_read_b64_tr_b16 v[36:37], v12 offset:14336
    ds_read_b64_tr_b16 v[38:39], v12 offset:14848
    v_mfma_f32_32x32x16_bf16 v[112:127], v[48:51], v[60:63], v[112:127]
    ds_read_b64_tr_b16 v[40:41], v12 offset:18432
    ds_read_b64_tr_b16 v[42:43], v12 offset:18944
    s_waitcnt lgkmcnt(5)
    v_mfma_f32_32x32x16_bf16 v[80:95], v[68:71], v[64:67], v[80:95]
    ds_read_b64_tr_b16 v[44:45], v12 offset:22528
    ds_read_b64_tr_b16 v[46:47], v12 offset:23040
    v_mfma_f32_32x32x16_bf16 v[96:111], v[72:75], v[64:67], v[96:111]
    s_barrier
    ds_read_b128 v[48:51], v8 offset:8192
    ds_read_b64_tr_b16 v[52:53], v12 offset:24576
    ds_read_b64_tr_b16 v[54:55], v12 offset:25088
    v_mfma_f32_32x32x16_bf16 v[112:127], v[64:67], v[76:79], v[112:127]
    ds_read_b64_tr_b16 v[56:57], v12 offset:28672
    ds_read_b64_tr_b16 v[58:59], v12 offset:29184
    s_waitcnt lgkmcnt(5)
    v_mfma_f32_32x32x16_bf16 v[80:95], v[36:39], v[32:35], v[80:95]
    ds_read_b64_tr_b16 v[60:61], v12 offset:32768
    ds_read_b64_tr_b16 v[62:63], v12 offset:33280
    v_mfma_f32_32x32x16_bf16 v[96:111], v[40:43], v[32:35], v[96:111]
    ds_read_b128 v[64:67], v9 offset:8192
    ds_read_b64_tr_b16 v[68:69], v12 offset:26624
    ds_read_b64_tr_b16 v[70:71], v12 offset:27136
    v_mfma_f32_32x32x16_bf16 v[112:127], v[32:35], v[44:47], v[112:127]
    ds_read_b64_tr_b16 v[72:73], v12 offset:30720
    ds_read_b64_tr_b16 v[74:75], v12 offset:31232
    s_waitcnt lgkmcnt(5)
    v_mfma_f32_32x32x16_bf16 v[80:95], v[52:55], v[48:51], v[80:95]
    ds_read_b64_tr_b16 v[76:77], v12 offset:34816
    ds_read_b64_tr_b16 v[78:79], v12 offset:35328
    v_mfma_f32_32x32x16_bf16 v[96:111], v[56:59], v[48:51], v[96:111]
    s_barrier
    ds_read_b128 v[32:35], v10 offset:8192
    ds_read_b64_tr_b16 v[36:37], v12 offset:36864
    ds_read_b64_tr_b16 v[38:39], v12 offset:37376
    v_mfma_f32_32x32x16_bf16 v[112:127], v[48:51], v[60:63], v[112:127]
    ds_read_b64_tr_b16 v[40:41], v12 offset:40960
    ds_read_b64_tr_b16 v[42:43], v12 offset:41472
    s_waitcnt lgkmcnt(5)
    v_mfma_f32_32x32x16_bf16 v[80:95], v[68:71], v[64:67], v[80:95]
    ds_read_b64_tr_b16 v[44:45], v12 offset:45056
    ds_read_b64_tr_b16 v[46:47], v12 offset:45568
    v_mfma_f32_32x32x16_bf16 v[96:111], v[72:75], v[64:67], v[96:111]
    ds_read_b128 v[48:51], v11 offset:8192
    ds_read_b64_tr_b16 v[52:53], v12 offset:38912
    ds_read_b64_tr_b16 v[54:55], v12 offset:39424
    v_mfma_f32_32x32x16_bf16 v[112:127], v[64:67], v[76:79], v[112:127]
    ds_read_b64_tr_b16 v[56:57], v12 offset:43008
    ds_read_b64_tr_b16 v[58:59], v12 offset:43520
    s_waitcnt lgkmcnt(5)
    v_mfma_f32_32x32x16_bf16 v[80:95], v[36:39], v[32:35], v[80:95]
    ds_read_b64_tr_b16 v[60:61], v12 offset:47104
    ds_read_b64_tr_b16 v[62:63], v12 offset:47616
    v_mfma_f32_32x32x16_bf16 v[96:111], v[40:43], v[32:35], v[96:111]
    s_barrier
    ds_read_b128 v[64:67], v8 offset:16384
    ds_read_b64_tr_b16 v[68:69], v12 offset:49152
    ds_read_b64_tr_b16 v[70:71], v12 offset:49664
    v_mfma_f32_32x32x16_bf16 v[112:127], v[32:35], v[44:47], v[112:127]
    ds_read_b64_tr_b16 v[72:73], v12 offset:53248
    ds_read_b64_tr_b16 v[74:75], v12 offset:53760
    s_waitcnt lgkmcnt(5)
    v_mfma_f32_32x32x16_bf16 v[80:95], v[52:55], v[48:51], v[80:95]
    ds_read_b64_tr_b16 v[76:77], v12 offset:57344
    ds_read_b64_tr_b16 v[78:79], v12 offset:57856
    v_mfma_f32_32x32x16_bf16 v[96:111], v[56:59], v[48:51], v[96:111]
    ds_read_b128 v[32:35], v9 offset:16384
    ds_read_b64_tr_b16 v[36:37], v12 offset:51200
    ds_read_b64_tr_b16 v[38:39], v12 offset:51712
    v_mfma_f32_32x32x16_bf16 v[112:127], v[48:51], v[60:63], v[112:127]
    ds_read_b64_tr_b16 v[40:41], v12 offset:55296
    ds_read_b64_tr_b16 v[42:43], v12 offset:55808
    s_waitcnt lgkmcnt(5)
    v_mfma_f32_32x32x16_bf16 v[80:95], v[68:71], v[64:67], v[80:95]
    ds_read_b64_tr_b16 v[44:45], v12 offset:59392
    ds_read_b64_tr_b16 v[46:47], v12 offset:59904
    v_mfma_f32_32x32x16_bf16 v[96:111], v[72:75], v[64:67], v[96:111]
    s_barrier
    ds_read_b128 v[48:51], v10 offset:16384
    ds_read_b64_tr_b16 v[52:53], v13 offset:0
    ds_read_b64_tr_b16 v[54:55], v13 offset:512
    v_mfma_f32_32x32x16_bf16 v[112:127], v[64:67], v[76:79], v[112:127]
    ds_read_b64_tr_b16 v[56:57], v13 offset:4096
    ds_read_b64_tr_b16 v[58:59], v13 offset:4608
    s_waitcnt lgkmcnt(5)
    v_mfma_f32_32x32x16_bf16 v[80:95], v[36:39], v[32:35], v[80:95]
    ds_read_b64_tr_b16 v[60:61], v13 offset:8192
    ds_read_b64_tr_b16 v[62:63], v13 offset:8704
    v_mfma_f32_32x32x16_bf16 v[96:111], v[40:43], v[32:35], v[96:111]
    ds_read_b128 v[64:67], v11 offset:16384
    ds_read_b64_tr_b16 v[68:69], v13 offset:2048
    ds_read_b64_tr_b16 v[70:71], v13 offset:2560
    v_mfma_f32_32x32x16_bf16 v[112:127], v[32:35], v[44:47], v[112:127]
    ds_read_b64_tr_b16 v[72:73], v13 offset:6144
    ds_read_b64_tr_b16 v[74:75], v13 offset:6656
    s_waitcnt lgkmcnt(5)
    v_mfma_f32_32x32x16_bf16 v[80:95], v[52:55], v[48:51], v[80:95]
    ds_read_b64_tr_b16 v[76:77], v13 offset:10240
    ds_read_b64_tr_b16 v[78:79], v13 offset:10752
    v_mfma_f32_32x32x16_bf16 v[96:111], v[56:59], v[48:51], v[96:111]
    s_barrier
    ds_read_b128 v[32:35], v8 offset:24576
    ds_read_b64_tr_b16 v[36:37], v13 offset:12288
    ds_read_b64_tr_b16 v[38:39], v13 offset:12800
    v_mfma_f32_32x32x16_bf16 v[112:127], v[48:51], v[60:63], v[112:127]
    ds_read_b64_tr_b16 v[40:41], v13 offset:16384
    ds_read_b64_tr_b16 v[42:43], v13 offset:16896
    s_waitcnt lgkmcnt(5)
    v_mfma_f32_32x32x16_bf16 v[80:95], v[68:71], v[64:67], v[80:95]
    ds_read_b64_tr_b16 v[44:45], v13 offset:20480
    ds_read_b64_tr_b16 v[46:47], v13 offset:20992
    v_mfma_f32_32x32x16_bf16 v[96:111], v[72:75], v[64:67], v[96:111]
    ds_read_b128 v[48:51], v9 offset:24576
    ds_read_b64_tr_b16 v[52:53], v13 offset:14336
    ds_read_b64_tr_b16 v[54:55], v13 offset:14848
    v_mfma_f32_32x32x16_bf16 v[112:127], v[64:67], v[76:79], v[112:127]
    ds_read_b64_tr_b16 v[56:57], v13 offset:18432
    ds_read_b64_tr_b16 v[58:59], v13 offset:18944
    s_waitcnt lgkmcnt(5)
    v_mfma_f32_32x32x16_bf16 v[80:95], v[36:39], v[32:35], v[80:95]
    ds_read_b64_tr_b16 v[60:61], v13 offset:22528
    ds_read_b64_tr_b16 v[62:63], v13 offset:23040
    v_mfma_f32_32x32x16_bf16 v[96:111], v[40:43], v[32:35], v[96:111]
    s_barrier
    ds_read_b128 v[64:67], v10 offset:24576
    ds_read_b64_tr_b16 v[68:69], v13 offset:24576
    ds_read_b64_tr_b16 v[70:71], v13 offset:25088
    v_mfma_f32_32x32x16_bf16 v[112:127], v[32:35], v[44:47], v[112:127]
    ds_read_b64_tr_b16 v[72:73], v13 offset:28672
    ds_read_b64_tr_b16 v[74:75], v13 offset:29184
    s_waitcnt lgkmcnt(5)
    v_mfma_f32_32x32x16_bf16 v[80:95], v[52:55], v[48:51], v[80:95]
    ds_read_b64_tr_b16 v[76:77], v13 offset:32768
    ds_read_b64_tr_b16 v[78:79], v13 offset:33280
    v_mfma_f32_32x32x16_bf16 v[96:111], v[56:59], v[48:51], v[96:111]
    ds_read_b128 v[32:35], v11 offset:24576
    ds_read_b64_tr_b16 v[36:37], v13 offset:26624
    ds_read_b64_tr_b16 v[38:39], v13 offset:27136
    v_mfma_f32_32x32x16_bf16 v[112:127], v[48:51], v[60:63], v[112:127]
    ds_read_b64_tr_b16 v[40:41], v13 offset:30720
    ds_read_b64_tr_b16 v[42:43], v13 offset:31232
    s_waitcnt lgkmcnt(5)
    v_mfma_f32_32x32x16_bf16 v[80:95], v[68:71], v[64:67], v[80:95]
    ds_read_b64_tr_b16 v[44:45], v13 offset:34816
    ds_read_b64_tr_b16 v[46:47], v13 offset:35328
    v_mfma_f32_32x32x16_bf16 v[96:111], v[72:75], v[64:67], v[96:111]
    s_barrier
    ds_read_b128 v[48:51], v8 offset:0
    ds_read_b64_tr_b16 v[52:53], v13 offset:36864
    ds_read_b64_tr_b16 v[54:55], v13 offset:37376
    v_mfma_f32_32x32x16_bf16 v[112:127], v[64:67], v[76:79], v[112:127]
    ds_read_b64_tr_b16 v[56:57], v13 offset:40960
    ds_read_b64_tr_b16 v[58:59], v13 offset:41472
    s_waitcnt lgkmcnt(5)
    v_mfma_f32_32x32x16_bf16 v[80:95], v[36:39], v[32:35], v[80:95]
    ds_read_b64_tr_b16 v[60:61], v13 offset:45056
    ds_read_b64_tr_b16 v[62:63], v13 offset:45568
    v_mfma_f32_32x32x16_bf16 v[96:111], v[40:43], v[32:35], v[96:111]
    ds_read_b128 v[64:67], v9 offset:0
    ds_read_b64_tr_b16 v[68:69], v13 offset:38912
    ds_read_b64_tr_b16 v[70:71], v13 offset:39424
    v_mfma_f32_32x32x16_bf16 v[112:127], v[32:35], v[44:47], v[112:127]
    ds_read_b64_tr_b16 v[72:73], v13 offset:43008
    ds_read_b64_tr_b16 v[74:75], v13 offset:43520
    s_waitcnt lgkmcnt(5)
    v_mfma_f32_32x32x16_bf16 v[80:95], v[52:55], v[48:51], v[80:95]
    ds_read_b64_tr_b16 v[76:77], v13 offset:47104
    ds_read_b64_tr_b16 v[78:79], v13 offset:47616
    v_mfma_f32_32x32x16_bf16 v[96:111], v[56:59], v[48:51], v[96:111]
    s_barrier
    ds_read_b128 v[32:35], v10 offset:0
    ds_read_b64_tr_b16 v[36:37], v13 offset:49152
    ds_read_b64_tr_b16 v[38:39], v13 offset:49664
    v_mfma_f32_32x32x16_bf16 v[112:127], v[48:51], v[60:63], v[112:127]
    ds_read_b64_tr_b16 v[40:41], v13 offset:53248
    ds_read_b64_tr_b16 v[42:43], v13 offset:53760
    s_waitcnt lgkmcnt(5)
    v_mfma_f32_32x32x16_bf16 v[80:95], v[68:71], v[64:67], v[80:95]
    ds_read_b64_tr_b16 v[44:45], v13 offset:57344
    ds_read_b64_tr_b16 v[46:47], v13 offset:57856
    v_mfma_f32_32x32x16_bf16 v[96:111], v[72:75], v[64:67], v[96:111]
    ds_read_b128 v[48:51], v11 offset:0
    ds_read_b64_tr_b16 v[52:53], v13 offset:51200
    ds_read_b64_tr_b16 v[54:55], v13 offset:51712
    v_mfma_f32_32x32x16_bf16 v[112:127], v[64:67], v[76:79], v[112:127]
    ds_read_b64_tr_b16 v[56:57], v13 offset:55296
    ds_read_b64_tr_b16 v[58:59], v13 offset:55808
    s_waitcnt lgkmcnt(5)
    v_mfma_f32_32x32x16_bf16 v[80:95], v[36:39], v[32:35], v[80:95]
    ds_read_b64_tr_b16 v[60:61], v13 offset:59392
    ds_read_b64_tr_b16 v[62:63], v13 offset:59904
    v_mfma_f32_32x32x16_bf16 v[96:111], v[40:43], v[32:35], v[96:111]
    s_barrier
    ds_read_b128 v[64:67], v8 offset:8192
    ds_read_b64_tr_b16 v[68:69], v12 offset:0
    ds_read_b64_tr_b16 v[70:71], v12 offset:512
    v_mfma_f32_32x32x16_bf16 v[112:127], v[32:35], v[44:47], v[112:127]
    ds_read_b64_tr_b16 v[72:73], v12 offset:4096
    ds_read_b64_tr_b16 v[74:75], v12 offset:4608
    s_waitcnt lgkmcnt(5)
    v_mfma_f32_32x32x16_bf16 v[80:95], v[52:55], v[48:51], v[80:95]
    ds_read_b64_tr_b16 v[76:77], v12 offset:8192
    ds_read_b64_tr_b16 v[78:79], v12 offset:8704
    v_mfma_f32_32x32x16_bf16 v[96:111], v[56:59], v[48:51], v[96:111]
    ds_read_b128 v[32:35], v9 offset:8192
    ds_read_b64_tr_b16 v[36:37], v12 offset:2048
    ds_read_b64_tr_b16 v[38:39], v12 offset:2560
    v_mfma_f32_32x32x16_bf16 v[112:127], v[48:51], v[60:63], v[112:127]
    ds_read_b64_tr_b16 v[40:41], v12 offset:6144
    ds_read_b64_tr_b16 v[42:43], v12 offset:6656
    s_waitcnt lgkmcnt(5)
    v_mfma_f32_32x32x16_bf16 v[80:95], v[68:71], v[64:67], v[80:95]
    ds_read_b64_tr_b16 v[44:45], v12 offset:10240
    ds_read_b64_tr_b16 v[46:47], v12 offset:10752
    v_mfma_f32_32x32x16_bf16 v[96:111], v[72:75], v[64:67], v[96:111]
    s_barrier
    ds_read_b128 v[48:51], v10 offset:8192
    ds_read_b64_tr_b16 v[52:53], v12 offset:12288
    ds_read_b64_tr_b16 v[54:55], v12 offset:12800
    v_mfma_f32_32x32x16_bf16 v[112:127], v[64:67], v[76:79], v[112:127]
    ds_read_b64_tr_b16 v[56:57], v12 offset:16384
    ds_read_b64_tr_b16 v[58:59], v12 offset:16896
    s_waitcnt lgkmcnt(5)
    v_mfma_f32_32x32x16_bf16 v[80:95], v[36:39], v[32:35], v[80:95]
    ds_read_b64_tr_b16 v[60:61], v12 offset:20480
    ds_read_b64_tr_b16 v[62:63], v12 offset:20992
    v_mfma_f32_32x32x16_bf16 v[96:111], v[40:43], v[32:35], v[96:111]
    ds_read_b128 v[64:67], v11 offset:8192
    ds_read_b64_tr_b16 v[68:69], v12 offset:14336
    ds_read_b64_tr_b16 v[70:71], v12 offset:14848
    v_mfma_f32_32x32x16_bf16 v[112:127], v[32:35], v[44:47], v[112:127]
    ds_read_b64_tr_b16 v[72:73], v12 offset:18432
    ds_read_b64_tr_b16 v[74:75], v12 offset:18944
    s_waitcnt lgkmcnt(5)
    v_mfma_f32_32x32x16_bf16 v[80:95], v[52:55], v[48:51], v[80:95]
    ds_read_b64_tr_b16 v[76:77], v12 offset:22528
    ds_read_b64_tr_b16 v[78:79], v12 offset:23040
    v_mfma_f32_32x32x16_bf16 v[96:111], v[56:59], v[48:51], v[96:111]
    s_barrier
    ds_read_b128 v[32:35], v8 offset:16384
    ds_read_b64_tr_b16 v[36:37], v12 offset:24576
    ds_read_b64_tr_b16 v[38:39], v12 offset:25088
    v_mfma_f32_32x32x16_bf16 v[112:127], v[48:51], v[60:63], v[112:127]
    ds_read_b64_tr_b16 v[40:41], v12 offset:28672
    ds_read_b64_tr_b16 v[42:43], v12 offset:29184
    s_waitcnt lgkmcnt(5)
    v_mfma_f32_32x32x16_bf16 v[80:95], v[68:71], v[64:67], v[80:95]
    ds_read_b64_tr_b16 v[44:45], v12 offset:32768
    ds_read_b64_tr_b16 v[46:47], v12 offset:33280
    v_mfma_f32_32x32x16_bf16 v[96:111], v[72:75], v[64:67], v[96:111]
    ds_read_b128 v[48:51], v9 offset:16384
    ds_read_b64_tr_b16 v[52:53], v12 offset:26624
    ds_read_b64_tr_b16 v[54:55], v12 offset:27136
    v_mfma_f32_32x32x16_bf16 v[112:127], v[64:67], v[76:79], v[112:127]
    ds_read_b64_tr_b16 v[56:57], v12 offset:30720
    ds_read_b64_tr_b16 v[58:59], v12 offset:31232
    s_waitcnt lgkmcnt(5)
    v_mfma_f32_32x32x16_bf16 v[80:95], v[36:39], v[32:35], v[80:95]
    ds_read_b64_tr_b16 v[60:61], v12 offset:34816
    ds_read_b64_tr_b16 v[62:63], v12 offset:35328
    v_mfma_f32_32x32x16_bf16 v[96:111], v[40:43], v[32:35], v[96:111]
    s_barrier
    ds_read_b128 v[64:67], v10 offset:16384
    ds_read_b64_tr_b16 v[68:69], v12 offset:36864
    ds_read_b64_tr_b16 v[70:71], v12 offset:37376
    v_mfma_f32_32x32x16_bf16 v[112:127], v[32:35], v[44:47], v[112:127]
    ds_read_b64_tr_b16 v[72:73], v12 offset:40960
    ds_read_b64_tr_b16 v[74:75], v12 offset:41472
    s_waitcnt lgkmcnt(5)
    v_mfma_f32_32x32x16_bf16 v[80:95], v[52:55], v[48:51], v[80:95]
    ds_read_b64_tr_b16 v[76:77], v12 offset:45056
    ds_read_b64_tr_b16 v[78:79], v12 offset:45568
    v_mfma_f32_32x32x16_bf16 v[96:111], v[56:59], v[48:51], v[96:111]
    ds_read_b128 v[32:35], v11 offset:16384
    ds_read_b64_tr_b16 v[36:37], v12 offset:38912
    ds_read_b64_tr_b16 v[38:39], v12 offset:39424
    v_mfma_f32_32x32x16_bf16 v[112:127], v[48:51], v[60:63], v[112:127]
    ds_read_b64_tr_b16 v[40:41], v12 offset:43008
    ds_read_b64_tr_b16 v[42:43], v12 offset:43520
    s_waitcnt lgkmcnt(5)
    v_mfma_f32_32x32x16_bf16 v[80:95], v[68:71], v[64:67], v[80:95]
    ds_read_b64_tr_b16 v[44:45], v12 offset:47104
    ds_read_b64_tr_b16 v[46:47], v12 offset:47616
    v_mfma_f32_32x32x16_bf16 v[96:111], v[72:75], v[64:67], v[96:111]
    s_barrier
    ds_read_b128 v[48:51], v8 offset:24576
    ds_read_b64_tr_b16 v[52:53], v12 offset:49152
    ds_read_b64_tr_b16 v[54:55], v12 offset:49664
    v_mfma_f32_32x32x16_bf16 v[112:127], v[64:67], v[76:79], v[112:127]
    ds_read_b64_tr_b16 v[56:57], v12 offset:53248
    ds_read_b64_tr_b16 v[58:59], v12 offset:53760
    s_waitcnt lgkmcnt(5)
    v_mfma_f32_32x32x16_bf16 v[80:95], v[36:39], v[32:35], v[80:95]
    ds_read_b64_tr_b16 v[60:61], v12 offset:57344
    ds_read_b64_tr_b16 v[62:63], v12 offset:57856
    v_mfma_f32_32x32x16_bf16 v[96:111], v[40:43], v[32:35], v[96:111]
    ds_read_b128 v[64:67], v9 offset:24576
    ds_read_b64_tr_b16 v[68:69], v12 offset:51200
    ds_read_b64_tr_b16 v[70:71], v12 offset:51712
    v_mfma_f32_32x32x16_bf16 v[112:127], v[32:35], v[44:47], v[112:127]
    ds_read_b64_tr_b16 v[72:73], v12 offset:55296
    ds_read_b64_tr_b16 v[74:75], v12 offset:55808
    s_waitcnt lgkmcnt(5)
    v_mfma_f32_32x32x16_bf16 v[80:95], v[52:55], v[48:51], v[80:95]
    ds_read_b64_tr_b16 v[76:77], v12 offset:59392
    ds_read_b64_tr_b16 v[78:79], v12 offset:59904
    v_mfma_f32_32x32x16_bf16 v[96:111], v[56:59], v[48:51], v[96:111]
    s_barrier
    ds_read_b128 v[32:35], v10 offset:24576
    ds_read_b64_tr_b16 v[36:37], v13 offset:0
    ds_read_b64_tr_b16 v[38:39], v13 offset:512
    v_mfma_f32_32x32x16_bf16 v[112:127], v[48:51], v[60:63], v[112:127]
    ds_read_b64_tr_b16 v[40:41], v13 offset:4096
    ds_read_b64_tr_b16 v[42:43], v13 offset:4608
    s_waitcnt lgkmcnt(5)
    v_mfma_f32_32x32x16_bf16 v[80:95], v[68:71], v[64:67], v[80:95]
    ds_read_b64_tr_b16 v[44:45], v13 offset:8192
    ds_read_b64_tr_b16 v[46:47], v13 offset:8704
    v_mfma_f32_32x32x16_bf16 v[96:111], v[72:75], v[64:67], v[96:111]
    ds_read_b128 v[48:51], v11 offset:24576
    ds_read_b64_tr_b16 v[52:53], v13 offset:2048
    ds_read_b64_tr_b16 v[54:55], v13 offset:2560
    v_mfma_f32_32x32x16_bf16 v[112:127], v[64:67], v[76:79], v[112:127]
    ds_read_b64_tr_b16 v[56:57], v13 offset:6144
    ds_read_b64_tr_b16 v[58:59], v13 offset:6656
    s_waitcnt lgkmcnt(5)
    v_mfma_f32_32x32x16_bf16 v[80:95], v[36:39], v[32:35], v[80:95]
    ds_read_b64_tr_b16 v[60:61], v13 offset:10240
    ds_read_b64_tr_b16 v[62:63], v13 offset:10752
    v_mfma_f32_32x32x16_bf16 v[96:111], v[40:43], v[32:35], v[96:111]
    v_mfma_f32_32x32x16_bf16 v[112:127], v[32:35], v[44:47], v[112:127]
    s_waitcnt lgkmcnt(0)
    v_mfma_f32_32x32x16_bf16 v[80:95], v[52:55], v[48:51], v[80:95]
    v_mfma_f32_32x32x16_bf16 v[96:111], v[56:59], v[48:51], v[96:111]
    v_mfma_f32_32x32x16_bf16 v[112:127], v[48:51], v[60:63], v[112:127]
    s_nop 9
    v_mul_f32 v80, s43, v80
    v_mul_f32 v81, s43, v81
    v_mul_f32 v82, s43, v82
    v_mul_f32 v83, s43, v83
    v_mul_f32 v84, s43, v84
    v_mul_f32 v85, s43, v85
    v_mul_f32 v86, s43, v86
    v_mul_f32 v87, s43, v87
    v_mul_f32 v88, s43, v88
    v_mul_f32 v89, s43, v89
    v_mul_f32 v90, s43, v90
    v_mul_f32 v91, s43, v91
    v_mul_f32 v92, s43, v92
    v_mul_f32 v93, s43, v93
    v_mul_f32 v94, s43, v94
    v_mul_f32 v95, s43, v95
    v_cvt_pk_bf16_f32 v40, v80, v81
    v_cvt_pk_bf16_f32 v41, v82, v83
    v_cvt_pk_bf16_f32 v42, v84, v85
    v_cvt_pk_bf16_f32 v43, v86, v87
    s_add_u32 s44, s40, 0
    buffer_store_dwordx4 v[40:43], v2, s[16:19], s44 offen sc0 sc1
    v_cvt_pk_bf16_f32 v44, v88, v89
    v_cvt_pk_bf16_f32 v45, v90, v91
    v_cvt_pk_bf16_f32 v46, v92, v93
    v_cvt_pk_bf16_f32 v47, v94, v95
    s_add_u32 s44, s40, 65536
    buffer_store_dwordx4 v[44:47], v2, s[16:19], s44 offen sc0 sc1
    v_cvt_pk_bf16_f32 v48, v96, v97
    v_cvt_pk_bf16_f32 v49, v98, v99
    v_cvt_pk_bf16_f32 v50, v100, v101
    v_cvt_pk_bf16_f32 v51, v102, v103
    s_add_u32 s44, s40, 2097152
    buffer_store_dwordx4 v[48:51], v2, s[16:19], s44 offen sc0 sc1
    v_cvt_pk_bf16_f32 v52, v104, v105
    v_cvt_pk_bf16_f32 v53, v106, v107
    v_cvt_pk_bf16_f32 v54, v108, v109
    v_cvt_pk_bf16_f32 v55, v110, v111
    s_add_u32 s44, s40, 2162688
    buffer_store_dwordx4 v[52:55], v2, s[16:19], s44 offen sc0 sc1
    v_cvt_pk_bf16_f32 v56, v112, v113
    v_cvt_pk_bf16_f32 v57, v114, v115
    v_cvt_pk_bf16_f32 v58, v116, v117
    v_cvt_pk_bf16_f32 v59, v118, v119
    s_add_u32 s44, s40, 4194304
    buffer_store_dwordx4 v[56:59], v3, s[16:19], s44 offen offset:0 sc0 sc1
    v_cvt_pk_bf16_f32 v60, v120, v121
    v_cvt_pk_bf16_f32 v61, v122, v123
    v_cvt_pk_bf16_f32 v62, v124, v125
    v_cvt_pk_bf16_f32 v63, v126, v127
    s_add_u32 s44, s40, 4194304
    buffer_store_dwordx4 v[60:63], v3, s[16:19], s44 offen offset:512 sc0 sc1
L_k1_end:
    s_endpgm
.globl attn_kernel
.p2align 8
.type attn_kernel,@function
attn_kernel:
    s_cmp_ge_u32 s2, 256
    s_cbranch_scc1 L_k2_end
    s_load_dwordx2 s[20:21], s[0:1], 80
    s_load_dwordx2 s[4:5], s[0:1], 16
    s_load_dwordx2 s[6:7], s[0:1], 32
    s_load_dwordx2 s[22:23], s[0:1], 48
    s_load_dwordx2 s[50:51], s[0:1], 40
    s_load_dwordx2 s[52:53], s[0:1], 56

    v_and_b32 v1, 63, v0
    v_lshrrev_b32 v2, 6, v0
    s_and_b32 s24, s2, 7
    s_lshr_b32 s25, s2, 3
    v_readfirstlane_b32 s26, v2

    s_lshl_b32 s27, s24, 2
    s_and_b32 s28, s25, 3
    s_add_u32 s27, s27, s28
    s_lshr_b32 s28, s25, 2
    v_lshlrev_b32 v2, 4, v1
    s_and_b32 s41, s26, 7
    s_lshr_b32 s42, s26, 3
    s_lshl_b32 s29, s27, 16
    s_lshl_b32 s30, s41, 10
    s_lshl_b32 s32, s28, 13
    s_add_u32 s32, s32, s30
    s_add_u32 s32, s32, s29
    s_lshl_b32 s40, s42, 15
    s_add_u32 s30, s30, s40
    s_add_u32 s31, s29, s30
    s_lshl_b32 s43, s25, 14
    s_lshl_b32 s33, s26, 10
    s_add_u32 s43, s43, s33
    v_lshlrev_b32 v40, 2, v1
    v_add_u32 v40, 159744, v40
    v_mov_b32 v41, 0
    ds_write_b32 v40, v41
    s_waitcnt lgkmcnt(0)

    s_mov_b32 s16, s20
    s_mov_b32 s17, s21
    s_mov_b32 s18, 20971520
    s_mov_b32 s19, 0x00020000
    s_setprio 3
    v_mov_b32 v47, 159744
    v_mov_b32 v44, 1
    buffer_load_dwordx4 v[4:7], v2, s[16:19], s32 offen
    s_cmp_lt_u32 s26, 8
    s_cbranch_scc0 L_k2_n0
    s_lshl_b32 s36, s41, 10
    s_add_u32 s37, s36, s29

    s_add_u32 m0, s36, 0
    s_add_u32 s33, s37, 2097152
    buffer_load_dwordx4 v2, s[16:19], s33 offen lds
    s_add_u32 m0, s36, 32768
    s_add_u32 s33, s37, 2129920
    buffer_load_dwordx4 v2, s[16:19], s33 offen lds
    s_add_u32 m0, s36, 65536
    s_add_u32 s33, s37, 4194304
    buffer_load_dwordx4 v2, s[16:19], s33 offen lds
    s_add_u32 m0, s36, 98304
    s_add_u32 s33, s37, 4227072
    buffer_load_dwordx4 v2, s[16:19], s33 offen lds
L_k2_n0:
    s_barrier
    s_cmp_lt_u32 s26, 12
    s_cbranch_scc1 L_k2_noload
    s_sub_u32 s36, s26, 12
    s_lshl_b32 s37, s36, 15
    s_add_u32 s37, s37, 8192
    s_and_b32 s38, s36, 1
    s_lshl_b32 s38, s38, 15
    s_lshr_b32 s39, s36, 1
    s_mul_i32 s39, s39, 2097152
    s_add_u32 s38, s38, s39
    s_add_u32 s38, s38, s29
    s_add_u32 s38, s38, 2105344

    s_add_u32 m0, s37, 0
    s_add_u32 s33, s38, 0
    buffer_load_dwordx4 v2, s[16:19], s33 offen lds
    s_add_u32 m0, s37, 1024
    s_add_u32 s33, s38, 1024
    buffer_load_dwordx4 v2, s[16:19], s33 offen lds
    s_add_u32 m0, s37, 2048
    s_add_u32 s33, s38, 2048
    buffer_load_dwordx4 v2, s[16:19], s33 offen lds
    s_add_u32 m0, s37, 3072
    s_add_u32 s33, s38, 3072
    buffer_load_dwordx4 v2, s[16:19], s33 offen lds
    s_add_u32 m0, s37, 4096
    s_add_u32 s33, s38, 4096
    buffer_load_dwordx4 v2, s[16:19], s33 offen lds
    s_add_u32 m0, s37, 5120
    s_add_u32 s33, s38, 5120
    buffer_load_dwordx4 v2, s[16:19], s33 offen lds
    s_add_u32 m0, s37, 6144
    s_add_u32 s33, s38, 6144
    buffer_load_dwordx4 v2, s[16:19], s33 offen lds
    s_add_u32 m0, s37, 7168
    s_add_u32 s33, s38, 7168
    buffer_load_dwordx4 v2, s[16:19], s33 offen lds
    s_add_u32 m0, s37, 8192
    s_add_u32 s33, s38, 8192
    buffer_load_dwordx4 v2, s[16:19], s33 offen lds
    s_add_u32 m0, s37, 9216
    s_add_u32 s33, s38, 9216
    buffer_load_dwordx4 v2, s[16:19], s33 offen lds
    s_add_u32 m0, s37, 10240
    s_add_u32 s33, s38, 10240
    buffer_load_dwordx4 v2, s[16:19], s33 offen lds
    s_add_u32 m0, s37, 11264
    s_add_u32 s33, s38, 11264
    buffer_load_dwordx4 v2, s[16:19], s33 offen lds
    s_add_u32 m0, s37, 12288
    s_add_u32 s33, s38, 12288
    buffer_load_dwordx4 v2, s[16:19], s33 offen lds
    s_add_u32 m0, s37, 13312
    s_add_u32 s33, s38, 13312
    buffer_load_dwordx4 v2, s[16:19], s33 offen lds
    s_add_u32 m0, s37, 14336
    s_add_u32 s33, s38, 14336
    buffer_load_dwordx4 v2, s[16:19], s33 offen lds
    s_add_u32 m0, s37, 15360
    s_add_u32 s33, s38, 15360
    buffer_load_dwordx4 v2, s[16:19], s33 offen lds
    s_waitcnt vmcnt(8)
    s_mov_b64 exec, 1
    ds_add_u32 v47, v44 offset:4
    s_mov_b64 exec, -1
    s_add_u32 m0, s37, 16384
    s_add_u32 s33, s38, 16384
    buffer_load_dwordx4 v2, s[16:19], s33 offen lds
    s_add_u32 m0, s37, 17408
    s_add_u32 s33, s38, 17408
    buffer_load_dwordx4 v2, s[16:19], s33 offen lds
    s_add_u32 m0, s37, 18432
    s_add_u32 s33, s38, 18432
    buffer_load_dwordx4 v2, s[16:19], s33 offen lds
    s_add_u32 m0, s37, 19456
    s_add_u32 s33, s38, 19456
    buffer_load_dwordx4 v2, s[16:19], s33 offen lds
    s_add_u32 m0, s37, 20480
    s_add_u32 s33, s38, 20480
    buffer_load_dwordx4 v2, s[16:19], s33 offen lds
    s_add_u32 m0, s37, 21504
    s_add_u32 s33, s38, 21504
    buffer_load_dwordx4 v2, s[16:19], s33 offen lds
    s_add_u32 m0, s37, 22528
    s_add_u32 s33, s38, 22528
    buffer_load_dwordx4 v2, s[16:19], s33 offen lds
    s_add_u32 m0, s37, 23552
    s_add_u32 s33, s38, 23552
    buffer_load_dwordx4 v2, s[16:19], s33 offen lds
    s_waitcnt vmcnt(8)
    s_mov_b64 exec, 1
    ds_add_u32 v47, v44 offset:8
    s_mov_b64 exec, -1
    s_waitcnt vmcnt(0)
    s_mov_b64 exec, 1
    ds_add_u32 v47, v44 offset:12
    s_mov_b64 exec, -1
L_k2_noload:
    s_mov_b32 s8, s4
    s_mov_b32 s9, s5
    s_mov_b32 s10, 524288
    s_mov_b32 s11, 0x00020000
    s_mov_b32 s12, s6
    s_mov_b32 s13, s7
    s_mov_b32 s14, 1835008
    s_mov_b32 s15, 0x00020000
    s_mov_b32 s44, s22
    s_mov_b32 s45, s23
    s_mov_b32 s46, 1835008
    s_mov_b32 s47, 0x00020000
    s_lshl_b32 s48, s26, 8
    s_add_u32 s48, s48, s2
    s_lshr_b32 s37, s48, 1
    s_and_b32 s37, s37, 1
    s_lshl_b32 s37, s37, 2
    v_and_b32 v43, 7, v1
    v_xor_b32 v43, s37, v43
    v_lshlrev_b32 v43, 4, v43
    v_lshrrev_b32 v40, 3, v1
    s_mov_b32 s37, 229376
    v_mul_lo_u32 v40, v40, s37
    v_add_u32 v43, v43, v40

    v_and_b32 v3, 15, v1
    v_lshlrev_b32 v3, 4, v3
    v_lshrrev_b32 v40, 5, v1
    v_lshl_or_b32 v3, v40, 8, v3
    v_add_u32 v3, 0x10000, v3
    s_mov_b32 s34, 0x0000ffff
    s_mov_b32 s35, 0x0000ffff
    v_and_b32 v40, 27, v1
    v_mov_b32 v41, 0
    v_mov_b32 v42, 0x3f803f80
    v_cmp_eq_u32 vcc, 16, v40
    s_nop 1
    v_cndmask_b32 v41, v41, v42, vcc
    v_add_u32 v45, s40, v2
    v_add_u32 v46, s40, v3

    v_mov_b32 v16, v41
    v_mov_b32 v17, v41
    v_mov_b32 v18, v41
    v_mov_b32 v19, v41
    v_mov_b32 v20, v41
    v_mov_b32 v21, v41
    v_mov_b32 v22, v41
    v_mov_b32 v23, v41
    v_mov_b32 v24, v41
    v_mov_b32 v25, v41
    v_mov_b32 v26, v41
    v_mov_b32 v27, v41
    v_mov_b32 v28, v41
    v_mov_b32 v29, v41
    v_mov_b32 v30, v41
    v_mov_b32 v31, v41
    v_mov_b32 v96, 0
    v_mov_b32 v97, 0
    v_mov_b32 v98, 0
    v_mov_b32 v99, 0
    v_mov_b32 v100, 0
    v_mov_b32 v101, 0
    v_mov_b32 v102, 0
    v_mov_b32 v103, 0
    v_mov_b32 v104, 0
    v_mov_b32 v105, 0
    v_mov_b32 v106, 0
    v_mov_b32 v107, 0
    v_mov_b32 v108, 0
    v_mov_b32 v109, 0
    v_mov_b32 v110, 0
    v_mov_b32 v111, 0
    v_mov_b32 v36, 0
    v_mov_b32 v37, 0
    v_mov_b32 v38, 0
    v_mov_b32 v39, 0
    s_waitcnt vmcnt(0)
    s_cmp_lt_u32 s26, 8
    s_cbranch_scc0 L_k2_n1
    s_mov_b64 exec, 1
    ds_add_u32 v47, v44 offset:0
    s_mov_b64 exec, -1
L_k2_n1:
L_k2_p0:
    ds_read_b32 v40, v47 offset:0
    s_waitcnt lgkmcnt(0)
    v_readfirstlane_b32 s37, v40
    s_cmp_ge_u32 s37, 8
    s_cbranch_scc1 L_k2_p0_ok
    s_sleep 1
    s_branch L_k2_p0
L_k2_p0_ok:
    ds_read_b128 v[32:35], v2
    ds_read_b128 v[8:11], v45 offset:0
    ds_read_b128 v[12:15], v45 offset:1024
    s_mov_b64 exec, s[34:35]
    ds_read_b128 v[16:19], v46 offset:0
    ds_read_b128 v[20:23], v46 offset:512
    s_mov_b64 exec, -1
    s_waitcnt lgkmcnt(4)
    v_mfma_f32_32x32x16_bf16 v[80:95], v[32:35], v[4:7], 0
    s_nop 15
    v_max3_f32 v40, v80, v81, v82
    v_max3_f32 v40, v83, v84, v40
    v_max3_f32 v40, v85, v86, v40
    v_max3_f32 v40, v87, v88, v40
    v_max3_f32 v40, v89, v90, v40
    v_max3_f32 v40, v91, v92, v40
    v_max3_f32 v40, v93, v94, v40
    v_max_f32 v40, v40, v95
    v_mov_b32 v41, v40
    s_nop 1
    v_permlane32_swap_b32 v40, v41
    s_nop 1
    v_max_f32 v40, v40, v41
    v_sub_f32 v40, 0, v40
    v_mov_b32 v48, v40
    v_mov_b32 v49, v40
    v_mov_b32 v50, v40
    v_mov_b32 v51, v40
    v_mov_b32 v52, v40
    v_mov_b32 v53, v40
    v_mov_b32 v54, v40
    v_mov_b32 v55, v40
    v_mov_b32 v56, v40
    v_mov_b32 v57, v40
    v_mov_b32 v58, v40
    v_mov_b32 v59, v40
    v_mov_b32 v60, v40
    v_mov_b32 v61, v40
    v_mov_b32 v62, v40
    v_mov_b32 v63, v40
    v_mov_b32 v94, 0
    v_mov_b32 v95, 0
    s_waitcnt lgkmcnt(3)
    v_mfma_f32_32x32x16_bf16 v[64:79], v[8:11], v[4:7], v[48:63]
    s_mov_b32 s36, 0
    s_nop 10
L_k2_loop:
    v_exp_f32 v64, v64
    v_cvt_pk_bf16_f32 v39, v94, v95
    v_exp_f32 v65, v65
    s_waitcnt lgkmcnt(0)
    v_mfma_f32_32x32x16_bf16 v[80:95], v[12:15], v[4:7], v[48:63]
    s_cmp_lg_u32 s36, 4
    s_cbranch_scc1 L_k2_pr2
    s_setprio 2
L_k2_pr2:
    s_cmp_lg_u32 s36, 6
    s_cbranch_scc1 L_k2_pr1
    s_setprio 1
L_k2_pr1:
    s_cmp_lg_u32 s36, 7
    s_cbranch_scc1 L_k2_pr0
    s_setprio 0
L_k2_pr0:
    s_cmp_lt_u32 s36, 4
    s_cbranch_scc0 L_k2_pf2
    s_lshl_b32 s37, s36, 19
    s_add_u32 s37, s37, s43
    buffer_load_dwordx4 v[112:115], v2, s[12:15], s37 offen
    s_branch L_k2_pfd
L_k2_pf2:
    s_cmp_lg_u32 s36, 4
    s_cbranch_scc1 L_k2_pf3
    s_lshl_b32 s37, s48, 10
    buffer_load_dwordx4 v[112:115], v2, s[44:47], s37 offen
    s_branch L_k2_pfd
L_k2_pf3:
    s_cmp_lg_u32 s36, 6
    s_cbranch_scc1 L_k2_pfd
    s_cmp_ge_u32 s48, 1792
    s_cbranch_scc1 L_k2_pfd
    s_lshl_b32 s37, s48, 7
    s_add_u32 s37, s37, 18874368
    s_waitcnt vmcnt(0)
    buffer_store_dwordx4 v[112:115], v43, s[16:19], s37 offen sc0 sc1
L_k2_pfd:
    ds_read_b128 v[8:11], v45 offset:2048
    v_exp_f32 v66, v66
    v_exp_f32 v67, v67
    v_cvt_pk_bf16_f32 v32, v64, v65
    v_exp_f32 v68, v68
    v_exp_f32 v69, v69
    v_cvt_pk_bf16_f32 v33, v66, v67
    v_mfma_f32_32x32x16_bf16 v[96:111], v[28:31], v[36:39], v[96:111]
    s_mov_b64 exec, s[34:35]
    ds_read_b128 v[24:27], v46 offset:1024
    ds_read_b128 v[28:31], v46 offset:1536
    s_mov_b64 exec, -1
    v_exp_f32 v70, v70
    v_exp_f32 v71, v71
    v_cvt_pk_bf16_f32 v34, v68, v69
    v_exp_f32 v72, v72
    v_exp_f32 v73, v73
    v_cvt_pk_bf16_f32 v35, v70, v71
    v_exp_f32 v74, v74
    v_exp_f32 v75, v75
    v_mfma_f32_32x32x16_bf16 v[96:111], v[16:19], v[32:35], v[96:111]
    v_cvt_pk_bf16_f32 v36, v72, v73
    v_exp_f32 v76, v76
    v_exp_f32 v77, v77
    v_cvt_pk_bf16_f32 v37, v74, v75
    v_exp_f32 v78, v78
    v_exp_f32 v79, v79
    v_cvt_pk_bf16_f32 v38, v76, v77
    v_exp_f32 v80, v80
    v_cvt_pk_bf16_f32 v39, v78, v79
    v_exp_f32 v81, v81
    s_waitcnt lgkmcnt(0)
    v_mfma_f32_32x32x16_bf16 v[64:79], v[8:11], v[4:7], v[48:63]
    ds_read_b128 v[12:15], v45 offset:3072
    v_exp_f32 v82, v82
    v_exp_f32 v83, v83
    v_cvt_pk_bf16_f32 v32, v80, v81
    v_exp_f32 v84, v84
    v_exp_f32 v85, v85
    v_cvt_pk_bf16_f32 v33, v82, v83
    v_mfma_f32_32x32x16_bf16 v[96:111], v[20:23], v[36:39], v[96:111]
    s_mov_b64 exec, s[34:35]
    ds_read_b128 v[16:19], v46 offset:2048
    ds_read_b128 v[20:23], v46 offset:2560
    s_mov_b64 exec, -1
    v_exp_f32 v86, v86
    v_exp_f32 v87, v87
    v_cvt_pk_bf16_f32 v34, v84, v85
    v_exp_f32 v88, v88
    v_exp_f32 v89, v89
    v_cvt_pk_bf16_f32 v35, v86, v87
    v_exp_f32 v90, v90
    v_exp_f32 v91, v91
    v_mfma_f32_32x32x16_bf16 v[96:111], v[24:27], v[32:35], v[96:111]
    v_cvt_pk_bf16_f32 v36, v88, v89
    v_exp_f32 v92, v92
    v_exp_f32 v93, v93
    v_cvt_pk_bf16_f32 v37, v90, v91
    v_exp_f32 v94, v94
    v_exp_f32 v95, v95
    v_cvt_pk_bf16_f32 v38, v92, v93
    v_exp_f32 v64, v64
    v_cvt_pk_bf16_f32 v39, v94, v95
    v_exp_f32 v65, v65
    s_waitcnt lgkmcnt(0)
    v_mfma_f32_32x32x16_bf16 v[80:95], v[12:15], v[4:7], v[48:63]
    s_and_b32 s37, s36, 1
    s_cmp_eq_u32 s37, 0
    s_cbranch_scc1 L_k2_poll_ok
    s_cmp_eq_u32 s36, 7
    s_cbranch_scc1 L_k2_poll_ok
    v_add_u32 v47, 4, v47
L_k2_poll:
    ds_read_b32 v40, v47 offset:0
    s_waitcnt lgkmcnt(0)
    v_readfirstlane_b32 s37, v40
    s_cmp_ge_u32 s37, 4
    s_cbranch_scc1 L_k2_poll_ok
    s_sleep 1
    s_branch L_k2_poll
L_k2_poll_ok:
    ds_read_b128 v[8:11], v45 offset:4096
    v_exp_f32 v66, v66
    v_exp_f32 v67, v67
    v_cvt_pk_bf16_f32 v32, v64, v65
    v_exp_f32 v68, v68
    v_exp_f32 v69, v69
    v_cvt_pk_bf16_f32 v33, v66, v67
    v_mfma_f32_32x32x16_bf16 v[96:111], v[28:31], v[36:39], v[96:111]
    s_mov_b64 exec, s[34:35]
    ds_read_b128 v[24:27], v46 offset:3072
    ds_read_b128 v[28:31], v46 offset:3584
    s_mov_b64 exec, -1
    v_exp_f32 v70, v70
    v_exp_f32 v71, v71
    v_cvt_pk_bf16_f32 v34, v68, v69
    v_exp_f32 v72, v72
    v_exp_f32 v73, v73
    v_cvt_pk_bf16_f32 v35, v70, v71
    v_exp_f32 v74, v74
    v_exp_f32 v75, v75
    v_mfma_f32_32x32x16_bf16 v[96:111], v[16:19], v[32:35], v[96:111]
    v_cvt_pk_bf16_f32 v36, v72, v73
    v_exp_f32 v76, v76
    v_exp_f32 v77, v77
    v_cvt_pk_bf16_f32 v37, v74, v75
    v_exp_f32 v78, v78
    v_exp_f32 v79, v79
    v_cvt_pk_bf16_f32 v38, v76, v77
    v_exp_f32 v80, v80
    v_cvt_pk_bf16_f32 v39, v78, v79
    v_exp_f32 v81, v81
    s_waitcnt lgkmcnt(0)
    v_mfma_f32_32x32x16_bf16 v[64:79], v[8:11], v[4:7], v[48:63]
    ds_read_b128 v[12:15], v45 offset:5120
    v_exp_f32 v82, v82
    v_exp_f32 v83, v83
    v_cvt_pk_bf16_f32 v32, v80, v81
    v_exp_f32 v84, v84
    v_exp_f32 v85, v85
    v_cvt_pk_bf16_f32 v33, v82, v83
    v_mfma_f32_32x32x16_bf16 v[96:111], v[20:23], v[36:39], v[96:111]
    s_mov_b64 exec, s[34:35]
    ds_read_b128 v[16:19], v46 offset:4096
    ds_read_b128 v[20:23], v46 offset:4608
    s_mov_b64 exec, -1
    v_exp_f32 v86, v86
    v_exp_f32 v87, v87
    v_cvt_pk_bf16_f32 v34, v84, v85
    v_exp_f32 v88, v88
    v_exp_f32 v89, v89
    v_cvt_pk_bf16_f32 v35, v86, v87
    v_exp_f32 v90, v90
    v_exp_f32 v91, v91
    v_mfma_f32_32x32x16_bf16 v[96:111], v[24:27], v[32:35], v[96:111]
    v_cvt_pk_bf16_f32 v36, v88, v89
    v_exp_f32 v92, v92
    v_exp_f32 v93, v93
    v_cvt_pk_bf16_f32 v37, v90, v91
    v_exp_f32 v94, v94
    v_exp_f32 v95, v95
    v_cvt_pk_bf16_f32 v38, v92, v93
    v_add_u32 v45, 4096, v45
    v_add_u32 v46, 4096, v46
    s_add_u32 s36, s36, 1
    s_cmp_lt_u32 s36, 8
    s_cbranch_scc1 L_k2_loop

    v_cvt_pk_bf16_f32 v39, v94, v95
    buffer_load_dwordx4 v[112:115], v2, s[8:11], s43 offen
    s_getpc_b64 s[54:55]
L_k2_pc:
    s_add_u32 s54, s54, mid_kernel - L_k2_pc
    s_addc_u32 s55, s55, 0
    s_lshl_b32 s37, s25, 10
    s_cmp_lt_u32 s26, 1
    s_cbranch_scc0 L_k2_nopc
    s_cmp_lt_u32 s37, (L_mid_end - mid_kernel) & 0xfffffc00
    s_cbranch_scc0 L_k2_nopc
    v_add_u32 v40, s37, v2
    v_mov_b32 v41, s55
    v_add_co_u32 v40, vcc, s54, v40
    s_nop 1
    v_addc_co_u32 v41, vcc, 0, v41, vcc
    global_load_dwordx4 v[112:115], v[40:41], off
L_k2_nopc:
    s_mov_b32 s8, s50
    s_mov_b32 s9, s51
    s_mov_b32 s10, 3584
    s_mov_b32 s11, 0x00020000
    s_mov_b32 s12, s52
    s_mov_b32 s13, s53
    s_mov_b32 s14, 1024
    s_mov_b32 s15, 0x00020000
    s_and_b32 s37, s26, 3
    s_lshl_b32 s37, s37, 10
    buffer_load_dwordx4 v[112:115], v2, s[8:11], s37 offen
    buffer_load_dwordx4 v[112:115], v2, s[12:15], 0 offen
    s_nop 0
    v_mfma_f32_32x32x16_bf16 v[96:111], v[28:31], v[36:39], v[96:111]
    s_mul_i32 s36, s41, 3072
    s_add_u32 s36, s36, 135168
    v_add_u32 v40, s36, v2
    s_lshl_b32 s37, s41, 2
    s_add_u32 s37, s37, 159776
    v_mov_b32 v47, s37
    v_mov_b32 v41, 1
    s_waitcnt lgkmcnt(0)
    s_nop 8
    s_cmp_eq_u32 s42, 1
    s_cbranch_scc1 L_k2_hi
    ds_write_b128 v40, v[96:99]
    ds_write_b128 v40, v[100:103] offset:1024
    ds_write_b128 v40, v[104:107] offset:2048
    s_waitcnt lgkmcnt(0)
    ds_write_b32 v47, v41
    s_waitcnt lgkmcnt(0)

    s_endpgm
L_k2_hi:
    ds_read_b32 v41, v47
    s_waitcnt lgkmcnt(0)
    v_readfirstlane_b32 s37, v41
    s_cmp_eq_u32 s37, 1
    s_cbranch_scc1 L_k2_got
    s_sleep 2
    s_branch L_k2_hi

L_k2_got:
    ds_read_b128 v[64:67], v40
    ds_read_b128 v[68:71], v40 offset:1024
    ds_read_b128 v[72:75], v40 offset:2048
    s_waitcnt lgkmcnt(0)

    v_add_f32 v96, v96, v64
    v_add_f32 v97, v97, v65
    v_add_f32 v98, v98, v66
    v_add_f32 v99, v99, v67
    v_add_f32 v100, v100, v68
    v_add_f32 v101, v101, v69
    v_add_f32 v102, v102, v70
    v_add_f32 v103, v103, v71
    v_add_f32 v104, v104, v72
    v_max3_f32 v40, abs(v96), abs(v97), abs(v98)
    v_max3_f32 v40, abs(v99), abs(v100), v40
    v_max3_f32 v40, abs(v101), abs(v102), v40
    v_max_f32 v40, abs(v103), v40
    v_mov_b32 v41, 0x71800000
    v_mov_b32 v42, 0x7f800000
    v_add_f32 v43, v96, v97
    v_add_f32 v43, v43, v98
    v_add_f32 v43, v43, v99
    v_add_f32 v43, v43, v100
    v_add_f32 v43, v43, v101
    v_add_f32 v43, v43, v102
    v_add_f32 v43, v43, v103
    v_cmp_nlt_f32 vcc, v104, v41
    v_cmp_nlt_f32 s[36:37], v40, v42
    v_cmp_u_f32 s[38:39], v43, v43
    s_nop 1
    s_or_b64 s[36:37], vcc, s[36:37]
    s_or_b64 s[36:37], s[36:37], s[38:39]
    s_cbranch_scc1 L_k2_slow

L_k2_fin:
    v_rcp_f32 v40, v104
    s_lshl_b32 s36, s28, 2
    s_lshr_b32 s37, s41, 1
    s_add_u32 s36, s36, s37
    s_lshl_b32 s36, s36, 16
    s_lshl_b32 s37, s27, 11
    s_add_u32 s36, s36, s37
    s_and_b32 s37, s41, 1
    s_lshl_b32 s37, s37, 10
    s_add_u32 s36, s36, s37
    s_add_u32 s36, s36, 6291456

    v_mul_f32 v96, v96, v40
    v_mul_f32 v97, v97, v40
    v_mul_f32 v98, v98, v40
    v_mul_f32 v99, v99, v40
    v_mul_f32 v100, v100, v40
    v_mul_f32 v101, v101, v40
    v_mul_f32 v102, v102, v40
    v_mul_f32 v103, v103, v40
    v_cvt_pk_bf16_f32 v32, v96, v97
    v_cvt_pk_bf16_f32 v33, v98, v99
    v_cvt_pk_bf16_f32 v34, v100, v101
    v_cvt_pk_bf16_f32 v35, v102, v103
    buffer_store_dwordx4 v[32:35], v2, s[16:19], s36 offen sc0 sc1
L_k2_end:
    s_endpgm
L_k2_slow:
    v_mov_b32 v96, 0
    v_mov_b32 v97, 0
    v_mov_b32 v98, 0
    v_mov_b32 v99, 0
    v_mov_b32 v100, 0
    v_mov_b32 v101, 0
    v_mov_b32 v102, 0
    v_mov_b32 v103, 0
    v_mov_b32 v104, 0
    v_mov_b32 v105, 0
    v_mov_b32 v106, 0
    v_mov_b32 v107, 0
    v_mov_b32 v108, 0
    v_mov_b32 v109, 0
    v_mov_b32 v110, 0
    v_mov_b32 v111, 0
    v_mov_b32 v44, 0xff800000
    v_mov_b32 v45, v2
    v_mov_b32 v46, v3
    s_mov_b32 s40, 0

L_k2_slow_loop:
    ds_read_b128 v[8:11], v45
    s_mov_b64 exec, s[34:35]
    ds_read_b128 v[16:19], v46
    ds_read_b128 v[20:23], v46 offset:512
    s_mov_b64 exec, -1
    s_waitcnt lgkmcnt(0)
    v_mfma_f32_32x32x16_bf16 v[64:79], v[8:11], v[4:7], 0
    s_nop 15
    v_max3_f32 v40, v64, v65, v44

    v_max3_f32 v40, v66, v67, v40
    v_max3_f32 v40, v68, v69, v40
    v_max3_f32 v40, v70, v71, v40
    v_max3_f32 v40, v72, v73, v40
    v_max3_f32 v40, v74, v75, v40
    v_max3_f32 v40, v76, v77, v40
    v_max3_f32 v40, v78, v79, v40
    v_mov_b32 v41, v40
    s_nop 1
    v_permlane32_swap_b32 v40, v41
    s_nop 1
    v_max_f32 v40, v40, v41
    v_sub_f32 v41, v44, v40
    v_exp_f32 v41, v41
    v_mov_b32 v44, v40

    v_mul_f32 v96, v96, v41
    v_mul_f32 v97, v97, v41
    v_mul_f32 v98, v98, v41
    v_mul_f32 v99, v99, v41
    v_mul_f32 v100, v100, v41
    v_mul_f32 v101, v101, v41
    v_mul_f32 v102, v102, v41
    v_mul_f32 v103, v103, v41
    v_mul_f32 v104, v104, v41
    v_mul_f32 v105, v105, v41
    v_mul_f32 v106, v106, v41
    v_mul_f32 v107, v107, v41
    v_mul_f32 v108, v108, v41
    v_mul_f32 v109, v109, v41
    v_mul_f32 v110, v110, v41
    v_mul_f32 v111, v111, v41
    v_sub_f32 v64, v64, v40
    v_sub_f32 v65, v65, v40
    v_sub_f32 v66, v66, v40
    v_sub_f32 v67, v67, v40
    v_sub_f32 v68, v68, v40
    v_sub_f32 v69, v69, v40
    v_sub_f32 v70, v70, v40
    v_sub_f32 v71, v71, v40
    v_sub_f32 v72, v72, v40
    v_sub_f32 v73, v73, v40
    v_sub_f32 v74, v74, v40
    v_sub_f32 v75, v75, v40
    v_sub_f32 v76, v76, v40
    v_sub_f32 v77, v77, v40
    v_sub_f32 v78, v78, v40
    v_sub_f32 v79, v79, v40
    v_exp_f32 v64, v64
    v_exp_f32 v65, v65
    v_exp_f32 v66, v66
    v_exp_f32 v67, v67
    v_exp_f32 v68, v68
    v_exp_f32 v69, v69
    v_exp_f32 v70, v70
    v_exp_f32 v71, v71
    v_exp_f32 v72, v72
    v_exp_f32 v73, v73
    v_exp_f32 v74, v74
    v_exp_f32 v75, v75
    v_exp_f32 v76, v76
    v_exp_f32 v77, v77
    v_exp_f32 v78, v78
    v_exp_f32 v79, v79
    s_nop 0
    v_cvt_pk_bf16_f32 v32, v64, v65
    v_cvt_pk_bf16_f32 v33, v66, v67
    v_cvt_pk_bf16_f32 v34, v68, v69
    v_cvt_pk_bf16_f32 v35, v70, v71
    v_cvt_pk_bf16_f32 v36, v72, v73
    v_cvt_pk_bf16_f32 v37, v74, v75
    v_cvt_pk_bf16_f32 v38, v76, v77
    v_cvt_pk_bf16_f32 v39, v78, v79
    s_nop 1
    v_mfma_f32_32x32x16_bf16 v[96:111], v[16:19], v[32:35], v[96:111]
    v_mfma_f32_32x32x16_bf16 v[96:111], v[20:23], v[36:39], v[96:111]
    s_nop 15
    v_add_u32 v45, 1024, v45
    v_add_u32 v46, 1024, v46
    s_add_u32 s40, s40, 1
    s_cmp_lt_u32 s40, 64
    s_cbranch_scc1 L_k2_slow_loop
    s_branch L_k2_fin

.globl mid_kernel
.p2align 8
.type mid_kernel,@function
mid_kernel:
    s_cmp_ge_u32 s2, 256
    s_cbranch_scc1 L_mid_end
    s_load_dwordx2 s[4:5], s[0:1], 16
    s_load_dwordx2 s[20:21], s[0:1], 80
    s_load_dwordx2 s[6:7], s[0:1], 0
    s_load_dwordx4 s[56:59], s[0:1], 32
    s_load_dwordx4 s[60:63], s[0:1], 56

    v_and_b32 v1, 63, v0
    v_lshrrev_b32 v2, 6, v0
    s_and_b32 s24, s2, 7
    s_lshr_b32 s25, s2, 3
    v_readfirstlane_b32 s26, v2

    s_lshl_b32 s27, s24, 2
    s_and_b32 s28, s25, 3
    s_add_u32 s27, s27, s28
    s_lshr_b32 s28, s25, 2
    s_and_b32 s29, s26, 3
    s_mul_i32 s42, s28, 448
    v_lshlrev_b32 v4, 4, v1
    s_cmp_ge_u32 s26, 4
    s_cbranch_scc0 L_mid_comp
    v_lshrrev_b32 v3, 3, v1
    v_and_b32 v4, 7, v1
    v_lshrrev_b32 v9, 4, v1

    v_and_b32 v5, 1, v9
    v_lshlrev_b32 v5, 2, v5
    v_xor_b32 v5, v5, v4
    v_lshlrev_b32 v5, 4, v5
    v_mul_u32_u24 v8, 1024, v3
    v_add_u32 v5, v5, v8

    v_lshlrev_b32 v4, 4, v1
    s_lshl_b32 s31, s29, 15
    s_lshl_b32 s33, s28, 7
    s_add_u32 s31, s31, s33
    s_mul_i32 s30, s27, 65536
    s_lshl_b32 s33, s29, 12
    s_add_u32 s30, s30, s33
    s_add_u32 s30, s30, 6291456
    s_lshl_b32 s32, s29, 13
    s_waitcnt lgkmcnt(0)

    s_mov_b32 s8, s4
    s_mov_b32 s9, s5
    s_mov_b32 s10, 524288
    s_mov_b32 s11, 0x00020000
    s_mov_b32 s16, s20
    s_mov_b32 s17, s21
    s_mov_b32 s18, 20971520
    s_mov_b32 s19, 0x00020000
    s_add_u32 m0, s32, 0
    s_add_u32 s33, s30, 0
    buffer_load_dwordx4 v4, s[16:19], s33 offen lds
    buffer_load_dwordx4 v4, s[16:19], s33 offen offset:1024 lds
    s_add_u32 m0, s32, 2048
    s_add_u32 s33, s31, 0
    buffer_load_dwordx4 v5, s[8:11], s33 offen lds
    s_add_u32 m0, s32, 3072
    s_add_u32 s33, s31, 8192
    buffer_load_dwordx4 v5, s[8:11], s33 offen lds
    s_add_u32 m0, s32, 4096
    s_add_u32 s33, s30, 2048
    buffer_load_dwordx4 v4, s[16:19], s33 offen lds
    buffer_load_dwordx4 v4, s[16:19], s33 offen offset:1024 lds
    s_add_u32 m0, s32, 6144
    s_add_u32 s33, s31, 16384
    buffer_load_dwordx4 v5, s[8:11], s33 offen lds
    s_add_u32 m0, s32, 7168
    s_add_u32 s33, s31, 24576
    buffer_load_dwordx4 v5, s[8:11], s33 offen lds
    s_add_u32 m0, s32, 32768
    s_add_u32 s33, s30, 16384
    buffer_load_dwordx4 v4, s[16:19], s33 offen lds
    buffer_load_dwordx4 v4, s[16:19], s33 offen offset:1024 lds
    s_add_u32 m0, s32, 34816
    s_add_u32 s33, s31, 131072
    buffer_load_dwordx4 v5, s[8:11], s33 offen lds
    s_add_u32 m0, s32, 35840
    s_add_u32 s33, s31, 139264
    buffer_load_dwordx4 v5, s[8:11], s33 offen lds
    s_add_u32 m0, s32, 36864
    s_add_u32 s33, s30, 18432
    buffer_load_dwordx4 v4, s[16:19], s33 offen lds
    buffer_load_dwordx4 v4, s[16:19], s33 offen offset:1024 lds
    s_add_u32 m0, s32, 38912
    s_add_u32 s33, s31, 147456
    buffer_load_dwordx4 v5, s[8:11], s33 offen lds
    s_add_u32 m0, s32, 39936
    s_add_u32 s33, s31, 155648
    buffer_load_dwordx4 v5, s[8:11], s33 offen lds
    s_waitcnt vmcnt(8)
    s_barrier
    s_add_u32 m0, s32, 65536
    s_add_u32 s33, s30, 32768
    buffer_load_dwordx4 v4, s[16:19], s33 offen lds
    buffer_load_dwordx4 v4, s[16:19], s33 offen offset:1024 lds
    s_add_u32 m0, s32, 67584
    s_add_u32 s33, s31, 262144
    buffer_load_dwordx4 v5, s[8:11], s33 offen lds
    s_add_u32 m0, s32, 68608
    s_add_u32 s33, s31, 270336
    buffer_load_dwordx4 v5, s[8:11], s33 offen lds
    s_add_u32 m0, s32, 69632
    s_add_u32 s33, s30, 34816
    buffer_load_dwordx4 v4, s[16:19], s33 offen lds
    buffer_load_dwordx4 v4, s[16:19], s33 offen offset:1024 lds
    s_add_u32 m0, s32, 71680
    s_add_u32 s33, s31, 278528
    buffer_load_dwordx4 v5, s[8:11], s33 offen lds
    s_add_u32 m0, s32, 72704
    s_add_u32 s33, s31, 286720
    buffer_load_dwordx4 v5, s[8:11], s33 offen lds
    s_waitcnt vmcnt(8)
    s_barrier
    s_add_u32 m0, s32, 98304
    s_add_u32 s33, s30, 49152
    buffer_load_dwordx4 v4, s[16:19], s33 offen lds
    buffer_load_dwordx4 v4, s[16:19], s33 offen offset:1024 lds
    s_add_u32 m0, s32, 100352
    s_add_u32 s33, s31, 393216
    buffer_load_dwordx4 v5, s[8:11], s33 offen lds
    s_add_u32 m0, s32, 101376
    s_add_u32 s33, s31, 401408
    buffer_load_dwordx4 v5, s[8:11], s33 offen lds
    s_add_u32 m0, s32, 102400
    s_add_u32 s33, s30, 51200
    buffer_load_dwordx4 v4, s[16:19], s33 offen lds
    buffer_load_dwordx4 v4, s[16:19], s33 offen offset:1024 lds
    s_add_u32 m0, s32, 104448
    s_add_u32 s33, s31, 409600
    buffer_load_dwordx4 v5, s[8:11], s33 offen lds
    s_add_u32 m0, s32, 105472
    s_add_u32 s33, s31, 417792
    buffer_load_dwordx4 v5, s[8:11], s33 offen lds
    s_mov_b32 s33, 2341
    s_mov_b32 s34, 3584
    v_add_u32 v16, 0, v1
    v_mul_u32_u24 v17, s33, v16
    v_lshrrev_b32 v17, 16, v17
    v_mul_u32_u24 v18, 28, v17
    v_sub_u32 v18, v16, v18
    v_mul_u32_u24 v17, s34, v17
    v_lshl_add_u32 v8, v18, 4, v17
    v_add_u32 v16, 64, v1
    v_mul_u32_u24 v17, s33, v16
    v_lshrrev_b32 v17, 16, v17
    v_mul_u32_u24 v18, 28, v17
    v_sub_u32 v18, v16, v18
    v_mul_u32_u24 v17, s34, v17
    v_lshl_add_u32 v9, v18, 4, v17
    v_add_u32 v16, 128, v1
    v_mul_u32_u24 v17, s33, v16
    v_lshrrev_b32 v17, 16, v17
    v_mul_u32_u24 v18, 28, v17
    v_sub_u32 v18, v16, v18
    v_mul_u32_u24 v17, s34, v17
    v_lshl_add_u32 v10, v18, 4, v17
    v_add_u32 v16, 192, v1
    v_mul_u32_u24 v17, s33, v16
    v_lshrrev_b32 v17, 16, v17
    v_mul_u32_u24 v18, 28, v17
    v_sub_u32 v18, v16, v18
    v_mul_u32_u24 v17, s34, v17
    v_lshl_add_u32 v11, v18, 4, v17
    v_add_u32 v16, 256, v1
    v_mul_u32_u24 v17, s33, v16
    v_lshrrev_b32 v17, 16, v17
    v_mul_u32_u24 v18, 28, v17
    v_sub_u32 v18, v16, v18
    v_mul_u32_u24 v17, s34, v17
    v_lshl_add_u32 v12, v18, 4, v17
    v_add_u32 v16, 320, v1
    v_mul_u32_u24 v17, s33, v16
    v_lshrrev_b32 v17, 16, v17
    v_mul_u32_u24 v18, 28, v17
    v_sub_u32 v18, v16, v18
    v_mul_u32_u24 v17, s34, v17
    v_lshl_add_u32 v13, v18, 4, v17
    v_add_u32 v16, 384, v1
    v_mul_u32_u24 v17, s33, v16
    v_lshrrev_b32 v17, 16, v17
    v_mul_u32_u24 v18, 28, v17
    v_sub_u32 v18, v16, v18
    v_mul_u32_u24 v17, s34, v17
    v_lshl_add_u32 v14, v18, 4, v17
    s_mul_i32 s53, s29, 57344
    s_add_u32 s53, s53, s42
    s_waitcnt vmcnt(8)
    s_barrier
    s_waitcnt vmcnt(0)
    s_barrier
    s_mul_i32 s32, s29, 7168
    s_mov_b32 s8, s56
    s_mov_b32 s9, s57
    s_mov_b32 s10, 1835008
    s_mov_b32 s11, 0x00020000
    s_mul_i32 s54, s25, 57344
    s_mul_i32 s55, s29, 14336
    s_add_u32 s54, s54, s55
    s_add_u32 s54, s54, 18874368

    s_add_u32 s41, s53, 0
    s_add_u32 m0, s32, 0
    s_nop 0
    buffer_load_dwordx4 v8, s[8:11], s41 offen lds
    s_add_u32 m0, s32, 1024
    s_nop 0
    buffer_load_dwordx4 v9, s[8:11], s41 offen lds
    s_add_u32 m0, s32, 2048
    s_nop 0
    buffer_load_dwordx4 v10, s[8:11], s41 offen lds
    s_add_u32 m0, s32, 3072
    s_nop 0
    buffer_load_dwordx4 v11, s[8:11], s41 offen lds
    s_add_u32 m0, s32, 4096
    s_nop 0
    buffer_load_dwordx4 v12, s[8:11], s41 offen lds
    s_add_u32 m0, s32, 5120
    s_nop 0
    buffer_load_dwordx4 v13, s[8:11], s41 offen lds
    s_add_u32 m0, s32, 6144
    s_nop 0
    buffer_load_dwordx4 v14, s[8:11], s41 offen lds
    s_add_u32 s41, s53, 229376
    s_add_u32 m0, s32, 28672
    s_nop 0
    buffer_load_dwordx4 v8, s[8:11], s41 offen lds
    s_add_u32 m0, s32, 29696
    s_nop 0
    buffer_load_dwordx4 v9, s[8:11], s41 offen lds
    s_add_u32 m0, s32, 30720
    s_nop 0
    buffer_load_dwordx4 v10, s[8:11], s41 offen lds
    s_add_u32 m0, s32, 31744
    s_nop 0
    buffer_load_dwordx4 v11, s[8:11], s41 offen lds
    s_add_u32 m0, s32, 32768
    s_nop 0
    buffer_load_dwordx4 v12, s[8:11], s41 offen lds
    s_add_u32 m0, s32, 33792
    s_nop 0
    buffer_load_dwordx4 v13, s[8:11], s41 offen lds
    s_add_u32 m0, s32, 34816
    s_nop 0
    buffer_load_dwordx4 v14, s[8:11], s41 offen lds
    s_barrier
    s_add_u32 s41, s53, 458752
    s_add_u32 m0, s32, 57344
    s_nop 0
    buffer_load_dwordx4 v8, s[8:11], s41 offen lds
    s_add_u32 m0, s32, 58368
    s_nop 0
    buffer_load_dwordx4 v9, s[8:11], s41 offen lds
    s_add_u32 m0, s32, 59392
    s_nop 0
    buffer_load_dwordx4 v10, s[8:11], s41 offen lds
    s_add_u32 m0, s32, 60416
    s_nop 0
    buffer_load_dwordx4 v11, s[8:11], s41 offen lds
    s_add_u32 m0, s32, 61440
    s_nop 0
    buffer_load_dwordx4 v12, s[8:11], s41 offen lds
    s_add_u32 m0, s32, 62464
    s_nop 0
    buffer_load_dwordx4 v13, s[8:11], s41 offen lds
    s_add_u32 m0, s32, 63488
    s_nop 0
    buffer_load_dwordx4 v14, s[8:11], s41 offen lds
    s_add_u32 s41, s53, 688128
    s_add_u32 m0, s32, 86016
    s_nop 0
    buffer_load_dwordx4 v8, s[8:11], s41 offen lds
    s_add_u32 m0, s32, 87040
    s_nop 0
    buffer_load_dwordx4 v9, s[8:11], s41 offen lds
    s_add_u32 m0, s32, 88064
    s_nop 0
    buffer_load_dwordx4 v10, s[8:11], s41 offen lds
    s_add_u32 m0, s32, 89088
    s_nop 0
    buffer_load_dwordx4 v11, s[8:11], s41 offen lds
    s_add_u32 m0, s32, 90112
    s_nop 0
    buffer_load_dwordx4 v12, s[8:11], s41 offen lds
    s_add_u32 m0, s32, 91136
    s_nop 0
    buffer_load_dwordx4 v13, s[8:11], s41 offen lds
    s_add_u32 m0, s32, 92160
    s_nop 0
    buffer_load_dwordx4 v14, s[8:11], s41 offen lds
    s_waitcnt vmcnt(21)
    s_barrier
    s_add_u32 s41, s53, 917504
    s_add_u32 m0, s32, 114688
    s_nop 0
    buffer_load_dwordx4 v8, s[8:11], s41 offen lds
    s_add_u32 m0, s32, 115712
    s_nop 0
    buffer_load_dwordx4 v9, s[8:11], s41 offen lds
    s_add_u32 m0, s32, 116736
    s_nop 0
    buffer_load_dwordx4 v10, s[8:11], s41 offen lds
    s_add_u32 m0, s32, 117760
    s_nop 0
    buffer_load_dwordx4 v11, s[8:11], s41 offen lds
    s_add_u32 m0, s32, 118784
    s_nop 0
    buffer_load_dwordx4 v12, s[8:11], s41 offen lds
    s_add_u32 m0, s32, 119808
    s_nop 0
    buffer_load_dwordx4 v13, s[8:11], s41 offen lds
    s_add_u32 m0, s32, 120832
    s_nop 0
    buffer_load_dwordx4 v14, s[8:11], s41 offen lds
    s_waitcnt vmcnt(21)
    s_barrier
    s_waitcnt vmcnt(14)
    s_barrier
    s_add_u32 s41, s53, 1146880
    s_add_u32 m0, s32, 0
    s_nop 0
    buffer_load_dwordx4 v8, s[8:11], s41 offen lds
    s_add_u32 m0, s32, 1024
    s_nop 0
    buffer_load_dwordx4 v9, s[8:11], s41 offen lds
    s_add_u32 m0, s32, 2048
    s_nop 0
    buffer_load_dwordx4 v10, s[8:11], s41 offen lds
    s_add_u32 m0, s32, 3072
    s_nop 0
    buffer_load_dwordx4 v11, s[8:11], s41 offen lds
    s_add_u32 m0, s32, 4096
    s_nop 0
    buffer_load_dwordx4 v12, s[8:11], s41 offen lds
    s_add_u32 m0, s32, 5120
    s_nop 0
    buffer_load_dwordx4 v13, s[8:11], s41 offen lds
    s_add_u32 m0, s32, 6144
    s_nop 0
    buffer_load_dwordx4 v14, s[8:11], s41 offen lds
    s_waitcnt vmcnt(14)
    s_barrier
    s_add_u32 s41, s53, 1376256
    s_add_u32 m0, s32, 28672
    s_nop 0
    buffer_load_dwordx4 v8, s[8:11], s41 offen lds
    s_add_u32 m0, s32, 29696
    s_nop 0
    buffer_load_dwordx4 v9, s[8:11], s41 offen lds
    s_add_u32 m0, s32, 30720
    s_nop 0
    buffer_load_dwordx4 v10, s[8:11], s41 offen lds
    s_add_u32 m0, s32, 31744
    s_nop 0
    buffer_load_dwordx4 v11, s[8:11], s41 offen lds
    s_add_u32 m0, s32, 32768
    s_nop 0
    buffer_load_dwordx4 v12, s[8:11], s41 offen lds
    s_add_u32 m0, s32, 33792
    s_nop 0
    buffer_load_dwordx4 v13, s[8:11], s41 offen lds
    s_add_u32 m0, s32, 34816
    s_nop 0
    buffer_load_dwordx4 v14, s[8:11], s41 offen lds
    s_waitcnt vmcnt(14)
    s_barrier
    s_add_u32 s41, s53, 1605632
    s_add_u32 m0, s32, 57344
    s_nop 0
    buffer_load_dwordx4 v8, s[8:11], s41 offen lds
    s_add_u32 m0, s32, 58368
    s_nop 0
    buffer_load_dwordx4 v9, s[8:11], s41 offen lds
    s_add_u32 m0, s32, 59392
    s_nop 0
    buffer_load_dwordx4 v10, s[8:11], s41 offen lds
    s_add_u32 m0, s32, 60416
    s_nop 0
    buffer_load_dwordx4 v11, s[8:11], s41 offen lds
    s_add_u32 m0, s32, 61440
    s_nop 0
    buffer_load_dwordx4 v12, s[8:11], s41 offen lds
    s_add_u32 m0, s32, 62464
    s_nop 0
    buffer_load_dwordx4 v13, s[8:11], s41 offen lds
    s_add_u32 m0, s32, 63488
    s_nop 0
    buffer_load_dwordx4 v14, s[8:11], s41 offen lds
    s_waitcnt vmcnt(14)
    s_barrier
    s_waitcnt vmcnt(7)
    s_barrier
    s_waitcnt vmcnt(0)
    s_barrier
    s_mul_i32 s31, s28, 229376
    s_lshl_b32 s33, s29, 12
    s_add_u32 s31, s31, s33
    s_add_u32 s31, s31, 18874368
    s_mul_i32 s30, s27, 229376
    s_add_u32 s30, s30, s33
    s_add_u32 s30, s30, 10485760
    s_lshl_b32 s32, s29, 12
    s_lshl_b32 s44, s27, 7
    s_add_u32 s44, s44, 18354176
    v_mov_b32 v16, 0
    s_barrier

    s_add_u32 m0, s32, 0
    s_add_u32 s33, s31, 0
    buffer_load_dwordx4 v4, s[16:19], s33 offen offset:0 lds
    buffer_load_dwordx4 v4, s[16:19], s33 offen offset:1024 lds
    buffer_load_dwordx4 v4, s[16:19], s33 offen offset:2048 lds
    buffer_load_dwordx4 v4, s[16:19], s33 offen offset:3072 lds
    s_add_u32 m0, s32, 16384
    s_add_u32 s33, s31, 16384
    buffer_load_dwordx4 v4, s[16:19], s33 offen offset:0 lds
    buffer_load_dwordx4 v4, s[16:19], s33 offen offset:1024 lds
    buffer_load_dwordx4 v4, s[16:19], s33 offen offset:2048 lds
    buffer_load_dwordx4 v4, s[16:19], s33 offen offset:3072 lds
    s_add_u32 m0, s32, 32768
    s_add_u32 s33, s31, 32768
    buffer_load_dwordx4 v4, s[16:19], s33 offen offset:0 lds
    buffer_load_dwordx4 v4, s[16:19], s33 offen offset:1024 lds
    buffer_load_dwordx4 v4, s[16:19], s33 offen offset:2048 lds
    buffer_load_dwordx4 v4, s[16:19], s33 offen offset:3072 lds
    s_add_u32 m0, s32, 49152
    s_add_u32 s33, s31, 49152
    buffer_load_dwordx4 v4, s[16:19], s33 offen offset:0 lds
    buffer_load_dwordx4 v4, s[16:19], s33 offen offset:1024 lds
    buffer_load_dwordx4 v4, s[16:19], s33 offen offset:2048 lds
    buffer_load_dwordx4 v4, s[16:19], s33 offen offset:3072 lds
    s_add_u32 m0, s32, 65536
    s_add_u32 s33, s31, 65536
    buffer_load_dwordx4 v4, s[16:19], s33 offen offset:0 lds
    buffer_load_dwordx4 v4, s[16:19], s33 offen offset:1024 lds
    buffer_load_dwordx4 v4, s[16:19], s33 offen offset:2048 lds
    buffer_load_dwordx4 v4, s[16:19], s33 offen offset:3072 lds
    s_waitcnt vmcnt(4)
    s_barrier
    s_barrier
    s_add_u32 m0, s32, 0
    s_add_u32 s33, s31, 81920
    buffer_load_dwordx4 v4, s[16:19], s33 offen offset:0 lds
    buffer_load_dwordx4 v4, s[16:19], s33 offen offset:1024 lds
    buffer_load_dwordx4 v4, s[16:19], s33 offen offset:2048 lds
    buffer_load_dwordx4 v4, s[16:19], s33 offen offset:3072 lds
    s_add_u32 m0, s32, 16384
    s_add_u32 s33, s31, 98304
    buffer_load_dwordx4 v4, s[16:19], s33 offen offset:0 lds
    buffer_load_dwordx4 v4, s[16:19], s33 offen offset:1024 lds
    buffer_load_dwordx4 v4, s[16:19], s33 offen offset:2048 lds
    buffer_load_dwordx4 v4, s[16:19], s33 offen offset:3072 lds
    s_add_u32 m0, s32, 32768
    s_add_u32 s33, s31, 114688
    buffer_load_dwordx4 v4, s[16:19], s33 offen offset:0 lds
    buffer_load_dwordx4 v4, s[16:19], s33 offen offset:1024 lds
    buffer_load_dwordx4 v4, s[16:19], s33 offen offset:2048 lds
    buffer_load_dwordx4 v4, s[16:19], s33 offen offset:3072 lds
    s_add_u32 m0, s32, 49152
    s_add_u32 s33, s31, 131072
    buffer_load_dwordx4 v4, s[16:19], s33 offen offset:0 lds
    buffer_load_dwordx4 v4, s[16:19], s33 offen offset:1024 lds
    buffer_load_dwordx4 v4, s[16:19], s33 offen offset:2048 lds
    buffer_load_dwordx4 v4, s[16:19], s33 offen offset:3072 lds
    s_barrier
    s_add_u32 m0, s32, 81920
    s_add_u32 s33, s30, 0
    buffer_load_dwordx4 v4, s[16:19], s33 offen offset:0 sc1 lds
    buffer_load_dwordx4 v4, s[16:19], s33 offen offset:1024 sc1 lds
    buffer_load_dwordx4 v4, s[16:19], s33 offen offset:2048 sc1 lds
    buffer_load_dwordx4 v4, s[16:19], s33 offen offset:3072 sc1 lds
    s_add_u32 m0, s32, 98304
    s_add_u32 s33, s30, 16384
    buffer_load_dwordx4 v4, s[16:19], s33 offen offset:0 sc1 lds
    buffer_load_dwordx4 v4, s[16:19], s33 offen offset:1024 sc1 lds
    buffer_load_dwordx4 v4, s[16:19], s33 offen offset:2048 sc1 lds
    buffer_load_dwordx4 v4, s[16:19], s33 offen offset:3072 sc1 lds
    s_add_u32 m0, s32, 114688
    s_add_u32 s33, s30, 32768
    buffer_load_dwordx4 v4, s[16:19], s33 offen offset:0 sc1 lds
    buffer_load_dwordx4 v4, s[16:19], s33 offen offset:1024 sc1 lds
    buffer_load_dwordx4 v4, s[16:19], s33 offen offset:2048 sc1 lds
    buffer_load_dwordx4 v4, s[16:19], s33 offen offset:3072 sc1 lds
    s_waitcnt vmcnt(8)
    s_barrier
    s_add_u32 m0, s32, 131072
    s_add_u32 s33, s30, 49152
    buffer_load_dwordx4 v4, s[16:19], s33 offen offset:0 sc1 lds
    buffer_load_dwordx4 v4, s[16:19], s33 offen offset:1024 sc1 lds
    buffer_load_dwordx4 v4, s[16:19], s33 offen offset:2048 sc1 lds
    buffer_load_dwordx4 v4, s[16:19], s33 offen offset:3072 sc1 lds
    s_add_u32 m0, s32, 147456
    s_add_u32 s33, s30, 65536
    buffer_load_dwordx4 v4, s[16:19], s33 offen offset:0 sc1 lds
    buffer_load_dwordx4 v4, s[16:19], s33 offen offset:1024 sc1 lds
    buffer_load_dwordx4 v4, s[16:19], s33 offen offset:2048 sc1 lds
    buffer_load_dwordx4 v4, s[16:19], s33 offen offset:3072 sc1 lds
    s_waitcnt vmcnt(12)
    s_barrier
    s_waitcnt vmcnt(8)
    s_barrier
    s_add_u32 m0, s32, 81920
    s_add_u32 s33, s30, 81920
    buffer_load_dwordx4 v4, s[16:19], s33 offen offset:0 sc1 lds
    buffer_load_dwordx4 v4, s[16:19], s33 offen offset:1024 sc1 lds
    buffer_load_dwordx4 v4, s[16:19], s33 offen offset:2048 sc1 lds
    buffer_load_dwordx4 v4, s[16:19], s33 offen offset:3072 sc1 lds
    s_waitcnt vmcnt(8)
    s_barrier
    s_add_u32 m0, s32, 98304
    s_add_u32 s33, s30, 98304
    buffer_load_dwordx4 v4, s[16:19], s33 offen offset:0 sc1 lds
    buffer_load_dwordx4 v4, s[16:19], s33 offen offset:1024 sc1 lds
    buffer_load_dwordx4 v4, s[16:19], s33 offen offset:2048 sc1 lds
    buffer_load_dwordx4 v4, s[16:19], s33 offen offset:3072 sc1 lds
    s_waitcnt vmcnt(8)
    s_barrier
    s_add_u32 m0, s32, 114688
    s_add_u32 s33, s30, 114688
    buffer_load_dwordx4 v4, s[16:19], s33 offen offset:0 sc1 lds
    buffer_load_dwordx4 v4, s[16:19], s33 offen offset:1024 sc1 lds
    buffer_load_dwordx4 v4, s[16:19], s33 offen offset:2048 sc1 lds
    buffer_load_dwordx4 v4, s[16:19], s33 offen offset:3072 sc1 lds
    s_waitcnt vmcnt(8)
    s_barrier
    s_add_u32 m0, s32, 131072
    s_add_u32 s33, s30, 131072
    buffer_load_dwordx4 v4, s[16:19], s33 offen offset:0 sc1 lds
    buffer_load_dwordx4 v4, s[16:19], s33 offen offset:1024 sc1 lds
    buffer_load_dwordx4 v4, s[16:19], s33 offen offset:2048 sc1 lds
    buffer_load_dwordx4 v4, s[16:19], s33 offen offset:3072 sc1 lds
    s_waitcnt vmcnt(8)
    s_barrier
    s_add_u32 m0, s32, 147456
    s_add_u32 s33, s30, 147456
    buffer_load_dwordx4 v4, s[16:19], s33 offen offset:0 sc1 lds
    buffer_load_dwordx4 v4, s[16:19], s33 offen offset:1024 sc1 lds
    buffer_load_dwordx4 v4, s[16:19], s33 offen offset:2048 sc1 lds
    buffer_load_dwordx4 v4, s[16:19], s33 offen offset:3072 sc1 lds
    s_add_u32 m0, s32, 65536
    s_add_u32 s33, s31, 147456
    buffer_load_dwordx4 v4, s[16:19], s33 offen offset:0 lds
    buffer_load_dwordx4 v4, s[16:19], s33 offen offset:1024 lds
    buffer_load_dwordx4 v4, s[16:19], s33 offen offset:2048 lds
    buffer_load_dwordx4 v4, s[16:19], s33 offen offset:3072 lds
    s_waitcnt vmcnt(12)
    s_barrier
    s_add_u32 m0, s32, 81920
    s_add_u32 s33, s30, 163840
    buffer_load_dwordx4 v4, s[16:19], s33 offen offset:0 sc1 lds
    buffer_load_dwordx4 v4, s[16:19], s33 offen offset:1024 sc1 lds
    buffer_load_dwordx4 v4, s[16:19], s33 offen offset:2048 sc1 lds
    buffer_load_dwordx4 v4, s[16:19], s33 offen offset:3072 sc1 lds
    s_add_u32 m0, s32, 0
    s_add_u32 s33, s31, 163840
    buffer_load_dwordx4 v4, s[16:19], s33 offen offset:0 lds
    buffer_load_dwordx4 v4, s[16:19], s33 offen offset:1024 lds
    buffer_load_dwordx4 v4, s[16:19], s33 offen offset:2048 lds
    buffer_load_dwordx4 v4, s[16:19], s33 offen offset:3072 lds
    s_waitcnt vmcnt(16)
    s_barrier
    s_add_u32 m0, s32, 98304
    s_add_u32 s33, s30, 180224
    buffer_load_dwordx4 v4, s[16:19], s33 offen offset:0 sc1 lds
    buffer_load_dwordx4 v4, s[16:19], s33 offen offset:1024 sc1 lds
    buffer_load_dwordx4 v4, s[16:19], s33 offen offset:2048 sc1 lds
    buffer_load_dwordx4 v4, s[16:19], s33 offen offset:3072 sc1 lds
    s_add_u32 m0, s32, 16384
    s_add_u32 s33, s31, 180224
    buffer_load_dwordx4 v4, s[16:19], s33 offen offset:0 lds
    buffer_load_dwordx4 v4, s[16:19], s33 offen offset:1024 lds
    buffer_load_dwordx4 v4, s[16:19], s33 offen offset:2048 lds
    buffer_load_dwordx4 v4, s[16:19], s33 offen offset:3072 lds
    s_waitcnt vmcnt(16)
    s_barrier
    s_add_u32 m0, s32, 114688
    s_add_u32 s33, s30, 196608
    buffer_load_dwordx4 v4, s[16:19], s33 offen offset:0 sc1 lds
    buffer_load_dwordx4 v4, s[16:19], s33 offen offset:1024 sc1 lds
    buffer_load_dwordx4 v4, s[16:19], s33 offen offset:2048 sc1 lds
    buffer_load_dwordx4 v4, s[16:19], s33 offen offset:3072 sc1 lds
    s_add_u32 m0, s32, 32768
    s_add_u32 s33, s31, 196608
    buffer_load_dwordx4 v4, s[16:19], s33 offen offset:0 lds
    buffer_load_dwordx4 v4, s[16:19], s33 offen offset:1024 lds
    buffer_load_dwordx4 v4, s[16:19], s33 offen offset:2048 lds
    buffer_load_dwordx4 v4, s[16:19], s33 offen offset:3072 lds
    s_waitcnt vmcnt(16)
    s_barrier
    s_add_u32 m0, s32, 131072
    s_add_u32 s33, s30, 212992
    buffer_load_dwordx4 v4, s[16:19], s33 offen offset:0 sc1 lds
    buffer_load_dwordx4 v4, s[16:19], s33 offen offset:1024 sc1 lds
    buffer_load_dwordx4 v4, s[16:19], s33 offen offset:2048 sc1 lds
    buffer_load_dwordx4 v4, s[16:19], s33 offen offset:3072 sc1 lds
    s_add_u32 m0, s32, 49152
    s_add_u32 s33, s31, 212992
    buffer_load_dwordx4 v4, s[16:19], s33 offen offset:0 lds
    buffer_load_dwordx4 v4, s[16:19], s33 offen offset:1024 lds
    buffer_load_dwordx4 v4, s[16:19], s33 offen offset:2048 lds
    buffer_load_dwordx4 v4, s[16:19], s33 offen offset:3072 lds
    s_waitcnt vmcnt(16)
    s_barrier
    s_waitcnt vmcnt(8)
    s_barrier
    s_waitcnt vmcnt(0)
    s_barrier
    s_endpgm
L_mid_comp:
    s_lshr_b32 s34, s26, 1
    s_and_b32 s35, s26, 1
    s_lshl_b32 s36, s34, 10
    v_add_u32 v6, s36, v4
    v_and_b32 v12, 31, v1
    v_lshrrev_b32 v13, 5, v1
    s_lshl_b32 s36, s35, 6

    v_and_b32 v14, 1, v1
    v_lshlrev_b32 v14, 4, v14
    v_bfe_u32 v15, v1, 1, 1
    v_lshl_or_b32 v14, v15, 3, v14
    v_bfe_u32 v15, v1, 4, 1
    v_lshl_or_b32 v14, v15, 5, v14

    v_lshlrev_b32 v7, 3, v13
    v_bfe_u32 v15, v1, 2, 2
    v_add_u32 v7, v7, v15
    v_lshlrev_b32 v7, 7, v7
    v_lshrrev_b32 v15, 1, v15
    v_lshlrev_b32 v15, 6, v15
    v_xor_b32 v14, v14, v15
    v_xor_b32 v14, s36, v14
    v_add_u32 v7, v7, v14
    v_add_u32 v7, 2048, v7
    v_add_u32 v8, 65536, v6
    v_add_u32 v9, 65536, v7
    v_add_u32 v10, 131072, v6
    v_add_u32 v11, 131072, v7
    s_lshl_b32 s36, s27, 1
    s_add_u32 s36, s36, s34
    s_lshl_b32 s36, s36, 15
    s_lshl_b32 s37, s28, 1
    s_add_u32 s37, s37, s35
    s_lshl_b32 s38, s37, 12
    s_lshl_b32 s46, s37, 8
    s_lshl_b32 s37, s37, 6
    s_lshr_b32 s47, s36, 3
    s_add_u32 s46, s46, s47
    s_add_u32 s46, s46, 17825792
    s_add_u32 s36, s36, s37
    s_lshl_b32 s39, s27, 16
    s_add_u32 s38, s38, s39
    s_lshl_b32 s39, s34, 10
    s_add_u32 s38, s38, s39
    s_add_u32 s38, s38, 8388608
    v_lshlrev_b32 v2, 10, v12
    v_lshl_or_b32 v2, v13, 4, v2
    v_lshlrev_b32 v3, 4, v13
    s_waitcnt lgkmcnt(0)

    s_mov_b32 s16, s20
    s_mov_b32 s17, s21
    s_mov_b32 s18, 20971520
    s_mov_b32 s19, 0x00020000
    v_lshlrev_b32 v14, 2, v1
    v_add_u32 v14, 163584, v14
    v_mov_b32 v15, 0
    ds_write_b32 v14, v15
    s_waitcnt lgkmcnt(0)
    s_mov_b32 s12, s6
    s_mov_b32 s13, s7
    s_mov_b32 s14, 2097152
    s_mov_b32 s15, 0x00020000
    buffer_load_dwordx4 v[112:115], v2, s[12:15], s36 offen
    buffer_load_dwordx4 v[116:119], v2, s[12:15], s36 offen offset:32
    v_mov_b32 v80, 0
    v_mov_b32 v81, 0
    v_mov_b32 v82, 0
    v_mov_b32 v83, 0
    v_mov_b32 v84, 0
    v_mov_b32 v85, 0
    v_mov_b32 v86, 0
    v_mov_b32 v87, 0
    v_mov_b32 v88, 0
    v_mov_b32 v89, 0
    v_mov_b32 v90, 0
    v_mov_b32 v91, 0
    v_mov_b32 v92, 0
    v_mov_b32 v93, 0
    v_mov_b32 v94, 0
    v_mov_b32 v95, 0
    v_mov_b32 v96, 0
    v_mov_b32 v97, 0
    v_mov_b32 v98, 0
    v_mov_b32 v99, 0
    v_mov_b32 v100, 0
    v_mov_b32 v101, 0
    v_mov_b32 v102, 0
    v_mov_b32 v103, 0
    v_mov_b32 v104, 0
    v_mov_b32 v105, 0
    v_mov_b32 v106, 0
    v_mov_b32 v107, 0
    v_mov_b32 v108, 0
    v_mov_b32 v109, 0
    v_mov_b32 v110, 0
    v_mov_b32 v111, 0
    s_barrier
    ds_read_b128 v[16:19], v6 offset:0
    ds_read_b64_tr_b16 v[20:21], v7 offset:0
    ds_read_b64_tr_b16 v[22:23], v7 offset:512
    ds_read_b128 v[24:27], v6 offset:4096
    ds_read_b64_tr_b16 v[28:29], v7 offset:4096
    ds_read_b64_tr_b16 v[30:31], v7 offset:4608
    ds_read_b128 v[32:35], v6 offset:8192
    ds_read_b64_tr_b16 v[36:37], v7 offset:8192
    ds_read_b64_tr_b16 v[38:39], v7 offset:8704
    ds_read_b128 v[40:43], v6 offset:12288
    ds_read_b64_tr_b16 v[44:45], v7 offset:12288
    ds_read_b64_tr_b16 v[46:47], v7 offset:12800
    ds_read_b128 v[48:51], v6 offset:16384
    ds_read_b64_tr_b16 v[52:53], v7 offset:16384
    ds_read_b64_tr_b16 v[54:55], v7 offset:16896
    s_waitcnt lgkmcnt(9)
    v_mfma_f32_32x32x16_bf16 v[80:95], v[20:23], v[16:19], v[80:95]
    ds_read_b128 v[56:59], v6 offset:20480
    ds_read_b64_tr_b16 v[60:61], v7 offset:20480
    ds_read_b64_tr_b16 v[62:63], v7 offset:20992
    v_mfma_f32_32x32x16_bf16 v[96:111], v[28:31], v[24:27], v[96:111]
    ds_read_b128 v[64:67], v6 offset:24576
    ds_read_b64_tr_b16 v[68:69], v7 offset:24576
    ds_read_b64_tr_b16 v[70:71], v7 offset:25088
    s_waitcnt lgkmcnt(9)
    v_mfma_f32_32x32x16_bf16 v[80:95], v[36:39], v[32:35], v[80:95]
    ds_read_b128 v[72:75], v6 offset:28672
    ds_read_b64_tr_b16 v[76:77], v7 offset:28672
    ds_read_b64_tr_b16 v[78:79], v7 offset:29184
    v_mfma_f32_32x32x16_bf16 v[96:111], v[44:47], v[40:43], v[96:111]
    s_barrier
    ds_read_b128 v[16:19], v6 offset:32768
    ds_read_b64_tr_b16 v[20:21], v7 offset:32768
    ds_read_b64_tr_b16 v[22:23], v7 offset:33280
    s_waitcnt lgkmcnt(9)
    v_mfma_f32_32x32x16_bf16 v[80:95], v[52:55], v[48:51], v[80:95]
    ds_read_b128 v[24:27], v6 offset:36864
    ds_read_b64_tr_b16 v[28:29], v7 offset:36864
    ds_read_b64_tr_b16 v[30:31], v7 offset:37376
    v_mfma_f32_32x32x16_bf16 v[96:111], v[60:63], v[56:59], v[96:111]
    ds_read_b128 v[32:35], v6 offset:40960
    ds_read_b64_tr_b16 v[36:37], v7 offset:40960
    ds_read_b64_tr_b16 v[38:39], v7 offset:41472
    s_waitcnt lgkmcnt(9)
    v_mfma_f32_32x32x16_bf16 v[80:95], v[68:71], v[64:67], v[80:95]
    ds_read_b128 v[40:43], v6 offset:45056
    ds_read_b64_tr_b16 v[44:45], v7 offset:45056
    ds_read_b64_tr_b16 v[46:47], v7 offset:45568
    v_mfma_f32_32x32x16_bf16 v[96:111], v[76:79], v[72:75], v[96:111]
    ds_read_b128 v[48:51], v6 offset:49152
    ds_read_b64_tr_b16 v[52:53], v7 offset:49152
    ds_read_b64_tr_b16 v[54:55], v7 offset:49664
    s_waitcnt lgkmcnt(9)
    v_mfma_f32_32x32x16_bf16 v[80:95], v[20:23], v[16:19], v[80:95]
    ds_read_b128 v[56:59], v6 offset:53248
    ds_read_b64_tr_b16 v[60:61], v7 offset:53248
    ds_read_b64_tr_b16 v[62:63], v7 offset:53760
    v_mfma_f32_32x32x16_bf16 v[96:111], v[28:31], v[24:27], v[96:111]
    ds_read_b128 v[64:67], v6 offset:57344
    ds_read_b64_tr_b16 v[68:69], v7 offset:57344
    ds_read_b64_tr_b16 v[70:71], v7 offset:57856
    s_waitcnt lgkmcnt(9)
    v_mfma_f32_32x32x16_bf16 v[80:95], v[36:39], v[32:35], v[80:95]
    ds_read_b128 v[72:75], v6 offset:61440
    ds_read_b64_tr_b16 v[76:77], v7 offset:61440
    ds_read_b64_tr_b16 v[78:79], v7 offset:61952
    v_mfma_f32_32x32x16_bf16 v[96:111], v[44:47], v[40:43], v[96:111]
    s_barrier
    ds_read_b128 v[16:19], v8 offset:0
    ds_read_b64_tr_b16 v[20:21], v9 offset:0
    ds_read_b64_tr_b16 v[22:23], v9 offset:512
    s_waitcnt lgkmcnt(9)
    v_mfma_f32_32x32x16_bf16 v[80:95], v[52:55], v[48:51], v[80:95]
    ds_read_b128 v[24:27], v8 offset:4096
    ds_read_b64_tr_b16 v[28:29], v9 offset:4096
    ds_read_b64_tr_b16 v[30:31], v9 offset:4608
    v_mfma_f32_32x32x16_bf16 v[96:111], v[60:63], v[56:59], v[96:111]
    ds_read_b128 v[32:35], v8 offset:8192
    ds_read_b64_tr_b16 v[36:37], v9 offset:8192
    ds_read_b64_tr_b16 v[38:39], v9 offset:8704
    s_waitcnt lgkmcnt(9)
    v_mfma_f32_32x32x16_bf16 v[80:95], v[68:71], v[64:67], v[80:95]
    ds_read_b128 v[40:43], v8 offset:12288
    ds_read_b64_tr_b16 v[44:45], v9 offset:12288
    ds_read_b64_tr_b16 v[46:47], v9 offset:12800
    v_mfma_f32_32x32x16_bf16 v[96:111], v[76:79], v[72:75], v[96:111]
    ds_read_b128 v[48:51], v8 offset:16384
    ds_read_b64_tr_b16 v[52:53], v9 offset:16384
    ds_read_b64_tr_b16 v[54:55], v9 offset:16896
    s_waitcnt lgkmcnt(9)
    v_mfma_f32_32x32x16_bf16 v[80:95], v[20:23], v[16:19], v[80:95]
    ds_read_b128 v[56:59], v8 offset:20480
    ds_read_b64_tr_b16 v[60:61], v9 offset:20480
    ds_read_b64_tr_b16 v[62:63], v9 offset:20992
    v_mfma_f32_32x32x16_bf16 v[96:111], v[28:31], v[24:27], v[96:111]
    ds_read_b128 v[64:67], v8 offset:24576
    ds_read_b64_tr_b16 v[68:69], v9 offset:24576
    ds_read_b64_tr_b16 v[70:71], v9 offset:25088
    s_waitcnt lgkmcnt(9)
    v_mfma_f32_32x32x16_bf16 v[80:95], v[36:39], v[32:35], v[80:95]
    ds_read_b128 v[72:75], v8 offset:28672
    ds_read_b64_tr_b16 v[76:77], v9 offset:28672
    ds_read_b64_tr_b16 v[78:79], v9 offset:29184
    v_mfma_f32_32x32x16_bf16 v[96:111], v[44:47], v[40:43], v[96:111]
    s_barrier
    ds_read_b128 v[16:19], v8 offset:32768
    ds_read_b64_tr_b16 v[20:21], v9 offset:32768
    ds_read_b64_tr_b16 v[22:23], v9 offset:33280
    s_waitcnt lgkmcnt(9)
    v_mfma_f32_32x32x16_bf16 v[80:95], v[52:55], v[48:51], v[80:95]
    ds_read_b128 v[24:27], v8 offset:36864
    ds_read_b64_tr_b16 v[28:29], v9 offset:36864
    ds_read_b64_tr_b16 v[30:31], v9 offset:37376
    v_mfma_f32_32x32x16_bf16 v[96:111], v[60:63], v[56:59], v[96:111]
    ds_read_b128 v[32:35], v8 offset:40960
    ds_read_b64_tr_b16 v[36:37], v9 offset:40960
    ds_read_b64_tr_b16 v[38:39], v9 offset:41472
    s_waitcnt lgkmcnt(9)
    v_mfma_f32_32x32x16_bf16 v[80:95], v[68:71], v[64:67], v[80:95]
    ds_read_b128 v[40:43], v8 offset:45056
    ds_read_b64_tr_b16 v[44:45], v9 offset:45056
    ds_read_b64_tr_b16 v[46:47], v9 offset:45568
    v_mfma_f32_32x32x16_bf16 v[96:111], v[76:79], v[72:75], v[96:111]
    ds_read_b128 v[48:51], v8 offset:49152
    ds_read_b64_tr_b16 v[52:53], v9 offset:49152
    ds_read_b64_tr_b16 v[54:55], v9 offset:49664
    s_waitcnt lgkmcnt(9)
    v_mfma_f32_32x32x16_bf16 v[80:95], v[20:23], v[16:19], v[80:95]
    ds_read_b128 v[56:59], v8 offset:53248
    ds_read_b64_tr_b16 v[60:61], v9 offset:53248
    ds_read_b64_tr_b16 v[62:63], v9 offset:53760
    v_mfma_f32_32x32x16_bf16 v[96:111], v[28:31], v[24:27], v[96:111]
    ds_read_b128 v[64:67], v8 offset:57344
    ds_read_b64_tr_b16 v[68:69], v9 offset:57344
    ds_read_b64_tr_b16 v[70:71], v9 offset:57856
    s_waitcnt lgkmcnt(9)
    v_mfma_f32_32x32x16_bf16 v[80:95], v[36:39], v[32:35], v[80:95]
    ds_read_b128 v[72:75], v8 offset:61440
    ds_read_b64_tr_b16 v[76:77], v9 offset:61440
    ds_read_b64_tr_b16 v[78:79], v9 offset:61952
    v_mfma_f32_32x32x16_bf16 v[96:111], v[44:47], v[40:43], v[96:111]
    s_waitcnt lgkmcnt(6)
    v_mfma_f32_32x32x16_bf16 v[80:95], v[52:55], v[48:51], v[80:95]
    v_mfma_f32_32x32x16_bf16 v[96:111], v[60:63], v[56:59], v[96:111]
    s_waitcnt lgkmcnt(0)
    v_mfma_f32_32x32x16_bf16 v[80:95], v[68:71], v[64:67], v[80:95]
    v_mfma_f32_32x32x16_bf16 v[96:111], v[76:79], v[72:75], v[96:111]
    s_waitcnt vmcnt(0)
    v_lshlrev_b32 v16, 16, v112
    v_and_b32 v17, 0xffff0000, v112
    v_lshlrev_b32 v18, 16, v113
    v_and_b32 v19, 0xffff0000, v113
    v_lshlrev_b32 v20, 16, v114
    v_and_b32 v21, 0xffff0000, v114
    v_lshlrev_b32 v22, 16, v115
    v_and_b32 v23, 0xffff0000, v115
    v_lshlrev_b32 v24, 16, v116
    v_and_b32 v25, 0xffff0000, v116
    v_lshlrev_b32 v26, 16, v117
    v_and_b32 v27, 0xffff0000, v117
    v_lshlrev_b32 v28, 16, v118
    v_and_b32 v29, 0xffff0000, v118
    v_lshlrev_b32 v30, 16, v119
    v_and_b32 v31, 0xffff0000, v119
    v_pk_add_f32 v[16:17], v[16:17], v[80:81]
    v_pk_add_f32 v[18:19], v[18:19], v[82:83]
    v_pk_add_f32 v[20:21], v[20:21], v[84:85]
    v_pk_add_f32 v[22:23], v[22:23], v[86:87]
    v_pk_add_f32 v[24:25], v[24:25], v[88:89]
    v_pk_add_f32 v[26:27], v[26:27], v[90:91]
    v_pk_add_f32 v[28:29], v[28:29], v[92:93]
    v_pk_add_f32 v[30:31], v[30:31], v[94:95]
    v_pk_add_f32 v[16:17], v[16:17], v[96:97]
    v_pk_add_f32 v[18:19], v[18:19], v[98:99]
    v_pk_add_f32 v[20:21], v[20:21], v[100:101]
    v_pk_add_f32 v[22:23], v[22:23], v[102:103]
    v_pk_add_f32 v[24:25], v[24:25], v[104:105]
    v_pk_add_f32 v[26:27], v[26:27], v[106:107]
    v_pk_add_f32 v[28:29], v[28:29], v[108:109]
    v_pk_add_f32 v[30:31], v[30:31], v[110:111]
    v_cvt_pk_bf16_f32 v32, v16, v17
    v_cvt_pk_bf16_f32 v33, v18, v19
    v_cvt_pk_bf16_f32 v34, v20, v21
    v_cvt_pk_bf16_f32 v35, v22, v23
    v_cvt_pk_bf16_f32 v36, v24, v25
    v_cvt_pk_bf16_f32 v37, v26, v27
    v_cvt_pk_bf16_f32 v38, v28, v29
    v_cvt_pk_bf16_f32 v39, v30, v31
    buffer_store_dwordx4 v[32:35], v4, s[16:19], s38 offen sc0 sc1
    buffer_store_dwordx4 v[36:39], v4, s[16:19], s38 offen offset:2048 sc0 sc1
    s_mov_b32 s39, 0x3f803f80
    v_mov_b32 v16, 0
    v_mov_b32 v17, 0
    v_mov_b32 v18, 0
    v_mov_b32 v19, 0
    v_dot2_f32_bf16 v16, v32, s39, v16
    v_dot2_f32_bf16 v18, v32, v32, v18
    v_dot2_f32_bf16 v17, v33, s39, v17
    v_dot2_f32_bf16 v19, v33, v33, v19
    v_dot2_f32_bf16 v16, v34, s39, v16
    v_dot2_f32_bf16 v18, v34, v34, v18
    v_dot2_f32_bf16 v17, v35, s39, v17
    v_dot2_f32_bf16 v19, v35, v35, v19
    v_dot2_f32_bf16 v16, v36, s39, v16
    v_dot2_f32_bf16 v18, v36, v36, v18
    v_dot2_f32_bf16 v17, v37, s39, v17
    v_dot2_f32_bf16 v19, v37, v37, v19
    v_dot2_f32_bf16 v16, v38, s39, v16
    v_dot2_f32_bf16 v18, v38, v38, v18
    v_dot2_f32_bf16 v17, v39, s39, v17
    v_dot2_f32_bf16 v19, v39, v39, v19
    s_nop 2
    v_add_f32 v16, v16, v17
    v_add_f32 v17, v18, v19
    v_mov_b32 v18, v16
    v_mov_b32 v19, v17
    s_nop 1
    v_permlane32_swap_b32 v16, v18
    v_permlane32_swap_b32 v17, v19
    s_nop 1
    v_add_f32 v16, v16, v18
    v_add_f32 v17, v17, v19
    v_lshlrev_b32 v3, 3, v12
    s_mov_b32 exec_hi, 0
    buffer_store_dwordx2 v[16:17], v3, s[16:19], s46 offen sc0 sc1
    s_mov_b32 exec_hi, -1
    v_mov_b32 v14, 163616
    v_mov_b32 v15, 1
    s_lshl_b32 s44, s27, 7
    s_add_u32 s44, s44, 18350080
    v_mov_b32 v16, 0
    s_waitcnt vmcnt(0)
    s_barrier
    s_mov_b64 exec, 1
    s_cmp_lg_u32 s26, 0
    s_cbranch_scc1 L_mid_nosig
    buffer_atomic_add v15, v16, s[16:19], s44 offen sc1

L_mid_nosig:
    s_mov_b64 exec, -1
    v_lshlrev_b32 v2, 4, v1
    v_lshrrev_b32 v4, 5, v1
    s_and_b32 s35, s26, 1
    s_lshr_b32 s37, s26, 1
    v_lshlrev_b32 v5, 4, v4
    s_lshl_b32 s36, s37, 5
    s_add_u32 s39, s42, s36
    v_and_b32 v3, 31, v1
    v_lshlrev_b32 v6, 3, v3
    v_lshl_or_b32 v6, v4, 11, v6
    s_lshl_b32 s43, s27, 1
    s_add_u32 s43, s43, s35
    s_lshl_b32 s43, s43, 12
    s_add_u32 s43, s43, 17825792
    s_lshl_b32 s40, s27, 16
    s_lshl_b32 s38, s37, 12
    s_add_u32 s40, s40, s38
    s_lshl_b32 s38, s35, 10
    s_add_u32 s40, s40, s38
    s_add_u32 s40, s40, 8388608
    s_waitcnt lgkmcnt(0)

    s_mov_b32 s12, s58
    s_mov_b32 s13, s59
    s_mov_b32 s14, 3584
    s_mov_b32 s15, 0x00020000
    buffer_load_dwordx4 v[88:91], v5, s[12:15], s39 offen offset:0
    buffer_load_dwordx4 v[92:95], v5, s[12:15], s39 offen offset:64
    buffer_load_dwordx4 v[96:99], v5, s[12:15], s39 offen offset:128
    buffer_load_dwordx4 v[100:103], v5, s[12:15], s39 offen offset:192
    buffer_load_dwordx4 v[104:107], v5, s[12:15], s39 offen offset:256
    buffer_load_dwordx4 v[108:111], v5, s[12:15], s39 offen offset:320
    buffer_load_dwordx4 v[112:115], v5, s[12:15], s39 offen offset:384
    v_mov_b32 v14, 163632
    s_cmp_eq_u32 s26, 0
    s_cbranch_scc1 L_mid_p1
L_mid_lf:
    ds_read_b32 v17, v14 offset:0
    s_waitcnt lgkmcnt(0)
    v_readfirstlane_b32 s45, v17
    s_cmp_ge_u32 s45, 1
    s_cbranch_scc1 L_mid_lf_ok
    s_sleep 1
    s_branch L_mid_lf
L_mid_lf_ok:
    s_waitcnt vmcnt(0)
    s_branch L_mid_go1b
L_mid_p1:
    s_mov_b32 s47, 0
L_mid_poll:
    buffer_load_dword v17, v16, s[16:19], s44 offen sc1
    s_waitcnt vmcnt(0)
    v_readfirstlane_b32 s45, v17
    s_cmp_ge_u32 s45, 8
    s_cbranch_scc1 L_mid_go
    s_add_u32 s47, s47, 1
    s_cmp_gt_u32 s47, 0x200000
    s_cbranch_scc1 L_mid_go
    s_sleep 2
    s_branch L_mid_poll

L_mid_go:
    ds_write_b32 v14, v15
L_mid_go1b:
    buffer_load_dwordx2 v[116:117], v6, s[16:19], s43 offen offset:0 sc1
    buffer_load_dwordx2 v[118:119], v6, s[16:19], s43 offen offset:256 sc1
    buffer_load_dwordx2 v[120:121], v6, s[16:19], s43 offen offset:512 sc1
    buffer_load_dwordx2 v[122:123], v6, s[16:19], s43 offen offset:768 sc1
    buffer_load_dwordx2 v[124:125], v6, s[16:19], s43 offen offset:1024 sc1
    buffer_load_dwordx2 v[126:127], v6, s[16:19], s43 offen offset:1280 sc1
    buffer_load_dwordx2 v[128:129], v6, s[16:19], s43 offen offset:1536 sc1
    buffer_load_dwordx2 v[130:131], v6, s[16:19], s43 offen offset:1792 sc1
    s_add_u32 s38, s40, 0
    buffer_load_dwordx4 v[24:27], v2, s[16:19], s38 offen offset:0 sc1
    buffer_load_dwordx4 v[28:31], v2, s[16:19], s38 offen offset:2048 sc1
    s_add_u32 s38, s40, 8192
    buffer_load_dwordx4 v[32:35], v2, s[16:19], s38 offen offset:0 sc1
    buffer_load_dwordx4 v[36:39], v2, s[16:19], s38 offen offset:2048 sc1
    s_add_u32 s38, s40, 16384
    buffer_load_dwordx4 v[40:43], v2, s[16:19], s38 offen offset:0 sc1
    buffer_load_dwordx4 v[44:47], v2, s[16:19], s38 offen offset:2048 sc1
    s_add_u32 s38, s40, 24576
    buffer_load_dwordx4 v[48:51], v2, s[16:19], s38 offen offset:0 sc1
    buffer_load_dwordx4 v[52:55], v2, s[16:19], s38 offen offset:2048 sc1
    s_add_u32 s38, s40, 32768
    buffer_load_dwordx4 v[56:59], v2, s[16:19], s38 offen offset:0 sc1
    buffer_load_dwordx4 v[60:63], v2, s[16:19], s38 offen offset:2048 sc1
    s_add_u32 s38, s40, 40960
    buffer_load_dwordx4 v[64:67], v2, s[16:19], s38 offen offset:0 sc1
    buffer_load_dwordx4 v[68:71], v2, s[16:19], s38 offen offset:2048 sc1
    s_add_u32 s38, s40, 49152
    buffer_load_dwordx4 v[72:75], v2, s[16:19], s38 offen offset:0 sc1
    buffer_load_dwordx4 v[76:79], v2, s[16:19], s38 offen offset:2048 sc1
    s_add_u32 s38, s40, 57344
    buffer_load_dwordx4 v[80:83], v2, s[16:19], s38 offen offset:0 sc1
    buffer_load_dwordx4 v[84:87], v2, s[16:19], s38 offen offset:2048 sc1
    v_and_b32 v12, 1, v1
    v_lshlrev_b32 v12, 4, v12
    v_bfe_u32 v13, v1, 1, 1
    v_lshl_or_b32 v12, v13, 3, v12
    v_bfe_u32 v13, v1, 4, 1
    v_lshl_or_b32 v12, v13, 5, v12

    v_xor_b32 v12, s36, v12
    v_lshlrev_b32 v13, 3, v4
    v_bfe_u32 v14, v1, 2, 2
    v_add_u32 v13, v13, v14
    v_add_u32 v13, s36, v13
    v_mul_u32_u24 v13, 448, v13
    v_add_u32 v8, v13, v12
    v_add_u32 v9, 57344, v8
    v_add_u32 v10, 114688, v8
    s_mul_i32 s40, s26, 14336
    s_add_u32 s40, s40, 106240
    v_add_u32 v6, s40, v2
    s_xor_b32 s41, s26, 2
    s_mul_i32 s41, s41, 14336
    s_add_u32 s41, s41, 106240
    v_add_u32 v7, s41, v2
    s_lshl_b32 s41, s26, 2
    s_add_u32 s41, s41, 163584
    v_mov_b32 v11, s41
    s_mul_i32 s40, s27, 229376
    s_mul_i32 s41, s28, 28672
    s_add_u32 s40, s40, s41
    s_lshl_b32 s41, s37, 11
    s_add_u32 s40, s40, s41
    s_lshl_b32 s41, s35, 10
    s_add_u32 s40, s40, s41
    s_add_u32 s40, s40, 10485760

    v_mov_b32 v152, 0
    v_mov_b32 v153, 0
    v_mov_b32 v154, 0
    v_mov_b32 v155, 0
    v_mov_b32 v156, 0
    v_mov_b32 v157, 0
    v_mov_b32 v158, 0
    v_mov_b32 v159, 0
    v_mov_b32 v168, 0
    v_mov_b32 v169, 0
    v_mov_b32 v170, 0
    v_mov_b32 v171, 0
    v_mov_b32 v172, 0
    v_mov_b32 v173, 0
    v_mov_b32 v174, 0
    v_mov_b32 v175, 0
    v_mov_b32 v184, 0
    v_mov_b32 v185, 0
    v_mov_b32 v186, 0
    v_mov_b32 v187, 0
    v_mov_b32 v188, 0
    v_mov_b32 v189, 0
    v_mov_b32 v190, 0
    v_mov_b32 v191, 0
    v_mov_b32 v200, 0
    v_mov_b32 v201, 0
    v_mov_b32 v202, 0
    v_mov_b32 v203, 0
    v_mov_b32 v204, 0
    v_mov_b32 v205, 0
    v_mov_b32 v206, 0
    v_mov_b32 v207, 0
    v_mov_b32 v216, 0
    v_mov_b32 v217, 0
    v_mov_b32 v218, 0
    v_mov_b32 v219, 0
    v_mov_b32 v220, 0
    v_mov_b32 v221, 0
    v_mov_b32 v222, 0
    v_mov_b32 v223, 0
    v_mov_b32 v232, 0
    v_mov_b32 v233, 0
    v_mov_b32 v234, 0
    v_mov_b32 v235, 0
    v_mov_b32 v236, 0
    v_mov_b32 v237, 0
    v_mov_b32 v238, 0
    v_mov_b32 v239, 0
    v_mov_b32 v248, 0
    v_mov_b32 v249, 0
    v_mov_b32 v250, 0
    v_mov_b32 v251, 0
    v_mov_b32 v252, 0
    v_mov_b32 v253, 0
    v_mov_b32 v254, 0
    v_mov_b32 v255, 0
    v_lshlrev_b32 v144, 16, v88
    v_and_b32 v145, 0xffff0000, v88
    v_lshlrev_b32 v146, 16, v89
    v_and_b32 v147, 0xffff0000, v89
    v_lshlrev_b32 v148, 16, v90
    v_and_b32 v149, 0xffff0000, v90
    v_lshlrev_b32 v150, 16, v91
    v_and_b32 v151, 0xffff0000, v91
    v_lshlrev_b32 v160, 16, v92
    v_and_b32 v161, 0xffff0000, v92
    v_lshlrev_b32 v162, 16, v93
    v_and_b32 v163, 0xffff0000, v93
    v_lshlrev_b32 v164, 16, v94
    v_and_b32 v165, 0xffff0000, v94
    v_lshlrev_b32 v166, 16, v95
    v_and_b32 v167, 0xffff0000, v95
    v_lshlrev_b32 v176, 16, v96
    v_and_b32 v177, 0xffff0000, v96
    v_lshlrev_b32 v178, 16, v97
    v_and_b32 v179, 0xffff0000, v97
    v_lshlrev_b32 v180, 16, v98
    v_and_b32 v181, 0xffff0000, v98
    v_lshlrev_b32 v182, 16, v99
    v_and_b32 v183, 0xffff0000, v99
    v_lshlrev_b32 v192, 16, v100
    v_and_b32 v193, 0xffff0000, v100
    v_lshlrev_b32 v194, 16, v101
    v_and_b32 v195, 0xffff0000, v101
    v_lshlrev_b32 v196, 16, v102
    v_and_b32 v197, 0xffff0000, v102
    v_lshlrev_b32 v198, 16, v103
    v_and_b32 v199, 0xffff0000, v103
    v_lshlrev_b32 v208, 16, v104
    v_and_b32 v209, 0xffff0000, v104
    v_lshlrev_b32 v210, 16, v105
    v_and_b32 v211, 0xffff0000, v105
    v_lshlrev_b32 v212, 16, v106
    v_and_b32 v213, 0xffff0000, v106
    v_lshlrev_b32 v214, 16, v107
    v_and_b32 v215, 0xffff0000, v107
    v_lshlrev_b32 v224, 16, v108
    v_and_b32 v225, 0xffff0000, v108
    v_lshlrev_b32 v226, 16, v109
    v_and_b32 v227, 0xffff0000, v109
    v_lshlrev_b32 v228, 16, v110
    v_and_b32 v229, 0xffff0000, v110
    v_lshlrev_b32 v230, 16, v111
    v_and_b32 v231, 0xffff0000, v111
    v_lshlrev_b32 v240, 16, v112
    v_and_b32 v241, 0xffff0000, v112
    v_lshlrev_b32 v242, 16, v113
    v_and_b32 v243, 0xffff0000, v113
    v_lshlrev_b32 v244, 16, v114
    v_and_b32 v245, 0xffff0000, v114
    v_lshlrev_b32 v246, 16, v115
    v_and_b32 v247, 0xffff0000, v115
    s_waitcnt vmcnt(16)
    v_pk_add_f32 v[116:117], v[116:117], v[124:125]
    v_pk_add_f32 v[118:119], v[118:119], v[126:127]
    v_pk_add_f32 v[120:121], v[120:121], v[128:129]
    v_pk_add_f32 v[122:123], v[122:123], v[130:131]
    v_pk_add_f32 v[116:117], v[116:117], v[120:121]
    v_pk_add_f32 v[118:119], v[118:119], v[122:123]
    v_pk_add_f32 v[116:117], v[116:117], v[118:119]
    v_mov_b32 v12, v116
    v_mov_b32 v13, v117
    s_nop 1
    v_permlane32_swap_b32 v116, v12
    v_permlane32_swap_b32 v117, v13
    s_nop 1
    v_add_f32 v116, v116, v12
    v_add_f32 v117, v117, v13
    v_mul_f32 v116, 0xbb000000, v116
    v_mul_f32 v117, 0x3b000000, v117
    v_fma_f32 v117, -v116, v116, v117
    v_max_f32 v117, 0, v117
    v_add_f32 v117, 0x3727c5ac, v117
    v_rsq_f32 v117, v117
    s_nop 0

    v_mul_f32 v12, v116, v117
    v_mov_b32 v13, v12
    v_mov_b32 v14, v117
    v_mov_b32 v15, v117
    s_waitcnt vmcnt(14)
    v_lshlrev_b32 v16, 16, v24
    v_and_b32 v17, 0xffff0000, v24
    v_lshlrev_b32 v18, 16, v25
    v_and_b32 v19, 0xffff0000, v25
    v_lshlrev_b32 v20, 16, v26
    v_and_b32 v21, 0xffff0000, v26
    v_lshlrev_b32 v22, 16, v27
    v_and_b32 v23, 0xffff0000, v27
    v_pk_fma_f32 v[16:17], v[16:17], v[14:15], v[12:13]
    v_pk_fma_f32 v[18:19], v[18:19], v[14:15], v[12:13]
    v_pk_fma_f32 v[20:21], v[20:21], v[14:15], v[12:13]
    v_pk_fma_f32 v[22:23], v[22:23], v[14:15], v[12:13]
    v_cvt_pk_bf16_f32 v24, v16, v17
    v_cvt_pk_bf16_f32 v25, v18, v19
    v_cvt_pk_bf16_f32 v26, v20, v21
    v_cvt_pk_bf16_f32 v27, v22, v23
    v_lshlrev_b32 v16, 16, v28
    v_and_b32 v17, 0xffff0000, v28
    v_lshlrev_b32 v18, 16, v29
    v_and_b32 v19, 0xffff0000, v29
    v_lshlrev_b32 v20, 16, v30
    v_and_b32 v21, 0xffff0000, v30
    v_lshlrev_b32 v22, 16, v31
    v_and_b32 v23, 0xffff0000, v31
    v_pk_fma_f32 v[16:17], v[16:17], v[14:15], v[12:13]
    v_pk_fma_f32 v[18:19], v[18:19], v[14:15], v[12:13]
    v_pk_fma_f32 v[20:21], v[20:21], v[14:15], v[12:13]
    v_pk_fma_f32 v[22:23], v[22:23], v[14:15], v[12:13]
    v_cvt_pk_bf16_f32 v28, v16, v17
    v_cvt_pk_bf16_f32 v29, v18, v19
    v_cvt_pk_bf16_f32 v30, v20, v21
    v_cvt_pk_bf16_f32 v31, v22, v23
    s_waitcnt vmcnt(12)
    v_lshlrev_b32 v16, 16, v32
    v_and_b32 v17, 0xffff0000, v32
    v_lshlrev_b32 v18, 16, v33
    v_and_b32 v19, 0xffff0000, v33
    v_lshlrev_b32 v20, 16, v34
    v_and_b32 v21, 0xffff0000, v34
    v_lshlrev_b32 v22, 16, v35
    v_and_b32 v23, 0xffff0000, v35
    v_pk_fma_f32 v[16:17], v[16:17], v[14:15], v[12:13]
    v_pk_fma_f32 v[18:19], v[18:19], v[14:15], v[12:13]
    v_pk_fma_f32 v[20:21], v[20:21], v[14:15], v[12:13]
    v_pk_fma_f32 v[22:23], v[22:23], v[14:15], v[12:13]
    v_cvt_pk_bf16_f32 v32, v16, v17
    v_cvt_pk_bf16_f32 v33, v18, v19
    v_cvt_pk_bf16_f32 v34, v20, v21
    v_cvt_pk_bf16_f32 v35, v22, v23
    v_lshlrev_b32 v16, 16, v36
    v_and_b32 v17, 0xffff0000, v36
    v_lshlrev_b32 v18, 16, v37
    v_and_b32 v19, 0xffff0000, v37
    v_lshlrev_b32 v20, 16, v38
    v_and_b32 v21, 0xffff0000, v38
    v_lshlrev_b32 v22, 16, v39
    v_and_b32 v23, 0xffff0000, v39
    v_pk_fma_f32 v[16:17], v[16:17], v[14:15], v[12:13]
    v_pk_fma_f32 v[18:19], v[18:19], v[14:15], v[12:13]
    v_pk_fma_f32 v[20:21], v[20:21], v[14:15], v[12:13]
    v_pk_fma_f32 v[22:23], v[22:23], v[14:15], v[12:13]
    v_cvt_pk_bf16_f32 v36, v16, v17
    v_cvt_pk_bf16_f32 v37, v18, v19
    v_cvt_pk_bf16_f32 v38, v20, v21
    v_cvt_pk_bf16_f32 v39, v22, v23
    s_waitcnt vmcnt(10)
    v_lshlrev_b32 v16, 16, v40
    v_and_b32 v17, 0xffff0000, v40
    v_lshlrev_b32 v18, 16, v41
    v_and_b32 v19, 0xffff0000, v41
    v_lshlrev_b32 v20, 16, v42
    v_and_b32 v21, 0xffff0000, v42
    v_lshlrev_b32 v22, 16, v43
    v_and_b32 v23, 0xffff0000, v43
    v_pk_fma_f32 v[16:17], v[16:17], v[14:15], v[12:13]
    v_pk_fma_f32 v[18:19], v[18:19], v[14:15], v[12:13]
    v_pk_fma_f32 v[20:21], v[20:21], v[14:15], v[12:13]
    v_pk_fma_f32 v[22:23], v[22:23], v[14:15], v[12:13]
    v_cvt_pk_bf16_f32 v40, v16, v17
    v_cvt_pk_bf16_f32 v41, v18, v19
    v_cvt_pk_bf16_f32 v42, v20, v21
    v_cvt_pk_bf16_f32 v43, v22, v23
    v_lshlrev_b32 v16, 16, v44
    v_and_b32 v17, 0xffff0000, v44
    v_lshlrev_b32 v18, 16, v45
    v_and_b32 v19, 0xffff0000, v45
    v_lshlrev_b32 v20, 16, v46
    v_and_b32 v21, 0xffff0000, v46
    v_lshlrev_b32 v22, 16, v47
    v_and_b32 v23, 0xffff0000, v47
    v_pk_fma_f32 v[16:17], v[16:17], v[14:15], v[12:13]
    v_pk_fma_f32 v[18:19], v[18:19], v[14:15], v[12:13]
    v_pk_fma_f32 v[20:21], v[20:21], v[14:15], v[12:13]
    v_pk_fma_f32 v[22:23], v[22:23], v[14:15], v[12:13]
    v_cvt_pk_bf16_f32 v44, v16, v17
    v_cvt_pk_bf16_f32 v45, v18, v19
    v_cvt_pk_bf16_f32 v46, v20, v21
    v_cvt_pk_bf16_f32 v47, v22, v23
    s_waitcnt lgkmcnt(0)
    s_barrier
    ds_read_b64_tr_b16 v[88:89], v8 offset:0
    ds_read_b64_tr_b16 v[90:91], v8 offset:1792
    ds_read_b64_tr_b16 v[92:93], v8 offset:64
    ds_read_b64_tr_b16 v[94:95], v8 offset:1856
    ds_read_b64_tr_b16 v[96:97], v8 offset:128
    ds_read_b64_tr_b16 v[98:99], v8 offset:1920
    ds_read_b64_tr_b16 v[100:101], v8 offset:192
    ds_read_b64_tr_b16 v[102:103], v8 offset:1984
    ds_read_b64_tr_b16 v[104:105], v8 offset:256
    ds_read_b64_tr_b16 v[106:107], v8 offset:2048
    ds_read_b64_tr_b16 v[108:109], v8 offset:320
    ds_read_b64_tr_b16 v[110:111], v8 offset:2112
    ds_read_b64_tr_b16 v[112:113], v8 offset:384
    ds_read_b64_tr_b16 v[114:115], v8 offset:2176
    ds_read_b64_tr_b16 v[116:117], v8 offset:7168
    ds_read_b64_tr_b16 v[118:119], v8 offset:8960
    s_waitcnt lgkmcnt(12)
    v_mfma_f32_32x32x16_bf16 v[144:159], v[88:91], v[24:27], v[144:159]
    s_waitcnt vmcnt(9)
    v_lshlrev_b32 v16, 16, v48
    v_lshlrev_b32 v18, 16, v49
    ds_read_b64_tr_b16 v[120:121], v8 offset:7232
    ds_read_b64_tr_b16 v[122:123], v8 offset:9024
    v_mfma_f32_32x32x16_bf16 v[160:175], v[92:95], v[24:27], v[160:175]
    v_and_b32 v17, 0xffff0000, v48
    v_and_b32 v19, 0xffff0000, v49
    ds_read_b64_tr_b16 v[124:125], v8 offset:7296
    ds_read_b64_tr_b16 v[126:127], v8 offset:9088
    s_waitcnt lgkmcnt(12)
    v_mfma_f32_32x32x16_bf16 v[176:191], v[96:99], v[24:27], v[176:191]
    v_fma_f32 v16, v16, v14, v12
    v_fma_f32 v18, v18, v14, v12
    ds_read_b64_tr_b16 v[128:129], v8 offset:7360
    ds_read_b64_tr_b16 v[130:131], v8 offset:9152
    v_mfma_f32_32x32x16_bf16 v[192:207], v[100:103], v[24:27], v[192:207]
    v_fma_f32 v17, v17, v14, v12
    v_fma_f32 v19, v19, v14, v12
    v_cvt_pk_bf16_f32 v48, v16, v17
    ds_read_b64_tr_b16 v[132:133], v8 offset:7424
    ds_read_b64_tr_b16 v[134:135], v8 offset:9216
    s_waitcnt lgkmcnt(12)
    v_mfma_f32_32x32x16_bf16 v[208:223], v[104:107], v[24:27], v[208:223]
    v_cvt_pk_bf16_f32 v49, v18, v19
    v_lshlrev_b32 v16, 16, v50
    ds_read_b64_tr_b16 v[136:137], v8 offset:7488
    ds_read_b64_tr_b16 v[138:139], v8 offset:9280
    v_mfma_f32_32x32x16_bf16 v[224:239], v[108:111], v[24:27], v[224:239]
    v_lshlrev_b32 v18, 16, v51
    v_and_b32 v17, 0xffff0000, v50
    ds_read_b64_tr_b16 v[140:141], v8 offset:7552
    ds_read_b64_tr_b16 v[142:143], v8 offset:9344
    s_waitcnt lgkmcnt(14)
    v_mfma_f32_32x32x16_bf16 v[240:255], v[112:115], v[24:27], v[240:255]
    v_and_b32 v19, 0xffff0000, v51
    v_fma_f32 v16, v16, v14, v12
    v_fma_f32 v18, v18, v14, v12
    s_barrier
    ds_read_b64_tr_b16 v[88:89], v8 offset:28672
    ds_read_b64_tr_b16 v[90:91], v8 offset:30464
    s_waitcnt lgkmcnt(12)
    v_mfma_f32_32x32x16_bf16 v[144:159], v[116:119], v[28:31], v[144:159]
    v_fma_f32 v17, v17, v14, v12
    v_fma_f32 v19, v19, v14, v12
    ds_read_b64_tr_b16 v[92:93], v8 offset:28736
    ds_read_b64_tr_b16 v[94:95], v8 offset:30528
    v_mfma_f32_32x32x16_bf16 v[160:175], v[120:123], v[28:31], v[160:175]
    v_cvt_pk_bf16_f32 v50, v16, v17
    v_cvt_pk_bf16_f32 v51, v18, v19
    ds_read_b64_tr_b16 v[96:97], v8 offset:28800
    ds_read_b64_tr_b16 v[98:99], v8 offset:30592
    s_waitcnt lgkmcnt(12)
    v_mfma_f32_32x32x16_bf16 v[176:191], v[124:127], v[28:31], v[176:191]
    s_waitcnt vmcnt(8)
    v_lshlrev_b32 v16, 16, v52
    v_lshlrev_b32 v18, 16, v53
    ds_read_b64_tr_b16 v[100:101], v8 offset:28864
    ds_read_b64_tr_b16 v[102:103], v8 offset:30656
    v_mfma_f32_32x32x16_bf16 v[192:207], v[128:131], v[28:31], v[192:207]
    v_and_b32 v17, 0xffff0000, v52
    v_and_b32 v19, 0xffff0000, v53
    ds_read_b64_tr_b16 v[104:105], v8 offset:28928
    ds_read_b64_tr_b16 v[106:107], v8 offset:30720
    s_waitcnt lgkmcnt(12)
    v_mfma_f32_32x32x16_bf16 v[208:223], v[132:135], v[28:31], v[208:223]
    v_fma_f32 v16, v16, v14, v12
    v_fma_f32 v18, v18, v14, v12
    ds_read_b64_tr_b16 v[108:109], v8 offset:28992
    ds_read_b64_tr_b16 v[110:111], v8 offset:30784
    v_mfma_f32_32x32x16_bf16 v[224:239], v[136:139], v[28:31], v[224:239]
    v_fma_f32 v17, v17, v14, v12
    v_fma_f32 v19, v19, v14, v12
    ds_read_b64_tr_b16 v[112:113], v8 offset:29056
    ds_read_b64_tr_b16 v[114:115], v8 offset:30848
    s_waitcnt lgkmcnt(14)
    v_mfma_f32_32x32x16_bf16 v[240:255], v[140:143], v[28:31], v[240:255]
    v_cvt_pk_bf16_f32 v52, v16, v17
    v_cvt_pk_bf16_f32 v53, v18, v19
    ds_read_b64_tr_b16 v[116:117], v8 offset:35840
    ds_read_b64_tr_b16 v[118:119], v8 offset:37632
    s_waitcnt lgkmcnt(12)
    v_mfma_f32_32x32x16_bf16 v[144:159], v[88:91], v[32:35], v[144:159]
    v_lshlrev_b32 v16, 16, v54
    v_lshlrev_b32 v18, 16, v55
    ds_read_b64_tr_b16 v[120:121], v8 offset:35904
    ds_read_b64_tr_b16 v[122:123], v8 offset:37696
    v_mfma_f32_32x32x16_bf16 v[160:175], v[92:95], v[32:35], v[160:175]
    v_and_b32 v17, 0xffff0000, v54
    v_and_b32 v19, 0xffff0000, v55
    ds_read_b64_tr_b16 v[124:125], v8 offset:35968
    ds_read_b64_tr_b16 v[126:127], v8 offset:37760
    s_waitcnt lgkmcnt(12)
    v_mfma_f32_32x32x16_bf16 v[176:191], v[96:99], v[32:35], v[176:191]
    v_fma_f32 v16, v16, v14, v12
    v_fma_f32 v18, v18, v14, v12
    ds_read_b64_tr_b16 v[128:129], v8 offset:36032
    ds_read_b64_tr_b16 v[130:131], v8 offset:37824
    v_mfma_f32_32x32x16_bf16 v[192:207], v[100:103], v[32:35], v[192:207]
    v_fma_f32 v17, v17, v14, v12
    v_fma_f32 v19, v19, v14, v12
    ds_read_b64_tr_b16 v[132:133], v8 offset:36096
    ds_read_b64_tr_b16 v[134:135], v8 offset:37888
    s_waitcnt lgkmcnt(12)
    v_mfma_f32_32x32x16_bf16 v[208:223], v[104:107], v[32:35], v[208:223]
    v_cvt_pk_bf16_f32 v54, v16, v17
    v_cvt_pk_bf16_f32 v55, v18, v19
    ds_read_b64_tr_b16 v[136:137], v8 offset:36160
    ds_read_b64_tr_b16 v[138:139], v8 offset:37952
    v_mfma_f32_32x32x16_bf16 v[224:239], v[108:111], v[32:35], v[224:239]
    s_waitcnt vmcnt(7)
    v_lshlrev_b32 v16, 16, v56
    v_lshlrev_b32 v18, 16, v57
    ds_read_b64_tr_b16 v[140:141], v8 offset:36224
    ds_read_b64_tr_b16 v[142:143], v8 offset:38016
    s_waitcnt lgkmcnt(14)
    v_mfma_f32_32x32x16_bf16 v[240:255], v[112:115], v[32:35], v[240:255]
    v_and_b32 v17, 0xffff0000, v56
    v_and_b32 v19, 0xffff0000, v57
    s_barrier
    ds_read_b64_tr_b16 v[88:89], v9 offset:0
    ds_read_b64_tr_b16 v[90:91], v9 offset:1792
    s_waitcnt lgkmcnt(12)
    v_mfma_f32_32x32x16_bf16 v[144:159], v[116:119], v[36:39], v[144:159]
    v_fma_f32 v16, v16, v14, v12
    v_fma_f32 v18, v18, v14, v12
    ds_read_b64_tr_b16 v[92:93], v9 offset:64
    ds_read_b64_tr_b16 v[94:95], v9 offset:1856
    v_mfma_f32_32x32x16_bf16 v[160:175], v[120:123], v[36:39], v[160:175]
    v_fma_f32 v17, v17, v14, v12
    v_fma_f32 v19, v19, v14, v12
    ds_read_b64_tr_b16 v[96:97], v9 offset:128
    ds_read_b64_tr_b16 v[98:99], v9 offset:1920
    s_waitcnt lgkmcnt(12)
    v_mfma_f32_32x32x16_bf16 v[176:191], v[124:127], v[36:39], v[176:191]
    v_cvt_pk_bf16_f32 v56, v16, v17
    v_cvt_pk_bf16_f32 v57, v18, v19
    ds_read_b64_tr_b16 v[100:101], v9 offset:192
    ds_read_b64_tr_b16 v[102:103], v9 offset:1984
    v_mfma_f32_32x32x16_bf16 v[192:207], v[128:131], v[36:39], v[192:207]
    v_lshlrev_b32 v16, 16, v58
    v_lshlrev_b32 v18, 16, v59
    ds_read_b64_tr_b16 v[104:105], v9 offset:256
    ds_read_b64_tr_b16 v[106:107], v9 offset:2048
    s_waitcnt lgkmcnt(12)
    v_mfma_f32_32x32x16_bf16 v[208:223], v[132:135], v[36:39], v[208:223]
    v_and_b32 v17, 0xffff0000, v58
    v_and_b32 v19, 0xffff0000, v59
    ds_read_b64_tr_b16 v[108:109], v9 offset:320
    ds_read_b64_tr_b16 v[110:111], v9 offset:2112
    v_mfma_f32_32x32x16_bf16 v[224:239], v[136:139], v[36:39], v[224:239]
    v_fma_f32 v16, v16, v14, v12
    v_fma_f32 v18, v18, v14, v12
    ds_read_b64_tr_b16 v[112:113], v9 offset:384
    ds_read_b64_tr_b16 v[114:115], v9 offset:2176
    s_waitcnt lgkmcnt(14)
    v_mfma_f32_32x32x16_bf16 v[240:255], v[140:143], v[36:39], v[240:255]
    v_fma_f32 v17, v17, v14, v12
    v_fma_f32 v19, v19, v14, v12
    ds_read_b64_tr_b16 v[116:117], v9 offset:7168
    ds_read_b64_tr_b16 v[118:119], v9 offset:8960
    s_waitcnt lgkmcnt(12)
    v_mfma_f32_32x32x16_bf16 v[144:159], v[88:91], v[40:43], v[144:159]
    v_cvt_pk_bf16_f32 v58, v16, v17
    v_cvt_pk_bf16_f32 v59, v18, v19
    ds_read_b64_tr_b16 v[120:121], v9 offset:7232
    ds_read_b64_tr_b16 v[122:123], v9 offset:9024
    v_mfma_f32_32x32x16_bf16 v[160:175], v[92:95], v[40:43], v[160:175]
    s_waitcnt vmcnt(6)
    v_lshlrev_b32 v16, 16, v60
    v_lshlrev_b32 v18, 16, v61
    ds_read_b64_tr_b16 v[124:125], v9 offset:7296
    ds_read_b64_tr_b16 v[126:127], v9 offset:9088
    s_waitcnt lgkmcnt(12)
    v_mfma_f32_32x32x16_bf16 v[176:191], v[96:99], v[40:43], v[176:191]
    v_and_b32 v17, 0xffff0000, v60
    v_and_b32 v19, 0xffff0000, v61
    ds_read_b64_tr_b16 v[128:129], v9 offset:7360
    ds_read_b64_tr_b16 v[130:131], v9 offset:9152
    v_mfma_f32_32x32x16_bf16 v[192:207], v[100:103], v[40:43], v[192:207]
    v_fma_f32 v16, v16, v14, v12
    v_fma_f32 v18, v18, v14, v12
    ds_read_b64_tr_b16 v[132:133], v9 offset:7424
    ds_read_b64_tr_b16 v[134:135], v9 offset:9216
    s_waitcnt lgkmcnt(12)
    v_mfma_f32_32x32x16_bf16 v[208:223], v[104:107], v[40:43], v[208:223]
    v_fma_f32 v17, v17, v14, v12
    v_fma_f32 v19, v19, v14, v12
    ds_read_b64_tr_b16 v[136:137], v9 offset:7488
    ds_read_b64_tr_b16 v[138:139], v9 offset:9280
    v_mfma_f32_32x32x16_bf16 v[224:239], v[108:111], v[40:43], v[224:239]
    v_cvt_pk_bf16_f32 v60, v16, v17
    v_cvt_pk_bf16_f32 v61, v18, v19
    ds_read_b64_tr_b16 v[140:141], v9 offset:7552
    ds_read_b64_tr_b16 v[142:143], v9 offset:9344
    s_waitcnt lgkmcnt(14)
    v_mfma_f32_32x32x16_bf16 v[240:255], v[112:115], v[40:43], v[240:255]
    v_lshlrev_b32 v16, 16, v62
    v_lshlrev_b32 v18, 16, v63
    s_barrier
    ds_read_b64_tr_b16 v[88:89], v9 offset:28672
    ds_read_b64_tr_b16 v[90:91], v9 offset:30464
    s_waitcnt lgkmcnt(12)
    v_mfma_f32_32x32x16_bf16 v[144:159], v[116:119], v[44:47], v[144:159]
    v_and_b32 v17, 0xffff0000, v62
    v_and_b32 v19, 0xffff0000, v63
    ds_read_b64_tr_b16 v[92:93], v9 offset:28736
    ds_read_b64_tr_b16 v[94:95], v9 offset:30528
    v_mfma_f32_32x32x16_bf16 v[160:175], v[120:123], v[44:47], v[160:175]
    v_fma_f32 v16, v16, v14, v12
    v_fma_f32 v18, v18, v14, v12
    ds_read_b64_tr_b16 v[96:97], v9 offset:28800
    ds_read_b64_tr_b16 v[98:99], v9 offset:30592
    s_waitcnt lgkmcnt(12)
    v_mfma_f32_32x32x16_bf16 v[176:191], v[124:127], v[44:47], v[176:191]
    v_fma_f32 v17, v17, v14, v12
    v_fma_f32 v19, v19, v14, v12
    ds_read_b64_tr_b16 v[100:101], v9 offset:28864
    ds_read_b64_tr_b16 v[102:103], v9 offset:30656
    v_mfma_f32_32x32x16_bf16 v[192:207], v[128:131], v[44:47], v[192:207]
    v_cvt_pk_bf16_f32 v62, v16, v17
    v_cvt_pk_bf16_f32 v63, v18, v19
    ds_read_b64_tr_b16 v[104:105], v9 offset:28928
    ds_read_b64_tr_b16 v[106:107], v9 offset:30720
    s_waitcnt lgkmcnt(12)
    v_mfma_f32_32x32x16_bf16 v[208:223], v[132:135], v[44:47], v[208:223]
    s_waitcnt vmcnt(5)
    v_lshlrev_b32 v16, 16, v64
    v_lshlrev_b32 v18, 16, v65
    ds_read_b64_tr_b16 v[108:109], v9 offset:28992
    ds_read_b64_tr_b16 v[110:111], v9 offset:30784
    v_mfma_f32_32x32x16_bf16 v[224:239], v[136:139], v[44:47], v[224:239]
    v_and_b32 v17, 0xffff0000, v64
    v_and_b32 v19, 0xffff0000, v65
    ds_read_b64_tr_b16 v[112:113], v9 offset:29056
    ds_read_b64_tr_b16 v[114:115], v9 offset:30848
    s_waitcnt lgkmcnt(14)
    v_mfma_f32_32x32x16_bf16 v[240:255], v[140:143], v[44:47], v[240:255]
    v_fma_f32 v16, v16, v14, v12
    v_fma_f32 v18, v18, v14, v12
    ds_read_b64_tr_b16 v[116:117], v9 offset:35840
    ds_read_b64_tr_b16 v[118:119], v9 offset:37632
    s_waitcnt lgkmcnt(12)
    v_mfma_f32_32x32x16_bf16 v[144:159], v[88:91], v[48:51], v[144:159]
    v_fma_f32 v17, v17, v14, v12
    v_fma_f32 v19, v19, v14, v12
    ds_read_b64_tr_b16 v[120:121], v9 offset:35904
    ds_read_b64_tr_b16 v[122:123], v9 offset:37696
    v_mfma_f32_32x32x16_bf16 v[160:175], v[92:95], v[48:51], v[160:175]
    v_cvt_pk_bf16_f32 v64, v16, v17
    v_cvt_pk_bf16_f32 v65, v18, v19
    ds_read_b64_tr_b16 v[124:125], v9 offset:35968
    ds_read_b64_tr_b16 v[126:127], v9 offset:37760
    s_waitcnt lgkmcnt(12)
    v_mfma_f32_32x32x16_bf16 v[176:191], v[96:99], v[48:51], v[176:191]
    v_lshlrev_b32 v16, 16, v66
    v_lshlrev_b32 v18, 16, v67
    ds_read_b64_tr_b16 v[128:129], v9 offset:36032
    ds_read_b64_tr_b16 v[130:131], v9 offset:37824
    v_mfma_f32_32x32x16_bf16 v[192:207], v[100:103], v[48:51], v[192:207]
    v_and_b32 v17, 0xffff0000, v66
    v_and_b32 v19, 0xffff0000, v67
    ds_read_b64_tr_b16 v[132:133], v9 offset:36096
    ds_read_b64_tr_b16 v[134:135], v9 offset:37888
    s_waitcnt lgkmcnt(12)
    v_mfma_f32_32x32x16_bf16 v[208:223], v[104:107], v[48:51], v[208:223]
    v_fma_f32 v16, v16, v14, v12
    v_fma_f32 v18, v18, v14, v12
    ds_read_b64_tr_b16 v[136:137], v9 offset:36160
    ds_read_b64_tr_b16 v[138:139], v9 offset:37952
    v_mfma_f32_32x32x16_bf16 v[224:239], v[108:111], v[48:51], v[224:239]
    v_fma_f32 v17, v17, v14, v12
    v_fma_f32 v19, v19, v14, v12
    ds_read_b64_tr_b16 v[140:141], v9 offset:36224
    ds_read_b64_tr_b16 v[142:143], v9 offset:38016
    s_waitcnt lgkmcnt(14)
    v_mfma_f32_32x32x16_bf16 v[240:255], v[112:115], v[48:51], v[240:255]
    v_cvt_pk_bf16_f32 v66, v16, v17
    v_cvt_pk_bf16_f32 v67, v18, v19
    s_barrier
    ds_read_b64_tr_b16 v[88:89], v10 offset:0
    ds_read_b64_tr_b16 v[90:91], v10 offset:1792
    s_waitcnt lgkmcnt(12)
    v_mfma_f32_32x32x16_bf16 v[144:159], v[116:119], v[52:55], v[144:159]
    s_waitcnt vmcnt(4)
    v_lshlrev_b32 v16, 16, v68
    v_lshlrev_b32 v18, 16, v69
    ds_read_b64_tr_b16 v[92:93], v10 offset:64
    ds_read_b64_tr_b16 v[94:95], v10 offset:1856
    v_mfma_f32_32x32x16_bf16 v[160:175], v[120:123], v[52:55], v[160:175]
    v_and_b32 v17, 0xffff0000, v68
    v_and_b32 v19, 0xffff0000, v69
    ds_read_b64_tr_b16 v[96:97], v10 offset:128
    ds_read_b64_tr_b16 v[98:99], v10 offset:1920
    s_waitcnt lgkmcnt(12)
    v_mfma_f32_32x32x16_bf16 v[176:191], v[124:127], v[52:55], v[176:191]
    v_fma_f32 v16, v16, v14, v12
    v_fma_f32 v18, v18, v14, v12
    ds_read_b64_tr_b16 v[100:101], v10 offset:192
    ds_read_b64_tr_b16 v[102:103], v10 offset:1984
    v_mfma_f32_32x32x16_bf16 v[192:207], v[128:131], v[52:55], v[192:207]
    v_fma_f32 v17, v17, v14, v12
    v_fma_f32 v19, v19, v14, v12
    v_cvt_pk_bf16_f32 v68, v16, v17
    ds_read_b64_tr_b16 v[104:105], v10 offset:256
    ds_read_b64_tr_b16 v[106:107], v10 offset:2048
    s_waitcnt lgkmcnt(12)
    v_mfma_f32_32x32x16_bf16 v[208:223], v[132:135], v[52:55], v[208:223]
    v_cvt_pk_bf16_f32 v69, v18, v19
    v_lshlrev_b32 v16, 16, v70
    ds_read_b64_tr_b16 v[108:109], v10 offset:320
    ds_read_b64_tr_b16 v[110:111], v10 offset:2112
    v_mfma_f32_32x32x16_bf16 v[224:239], v[136:139], v[52:55], v[224:239]
    v_lshlrev_b32 v18, 16, v71
    v_and_b32 v17, 0xffff0000, v70
    ds_read_b64_tr_b16 v[112:113], v10 offset:384
    ds_read_b64_tr_b16 v[114:115], v10 offset:2176
    s_waitcnt lgkmcnt(14)
    v_mfma_f32_32x32x16_bf16 v[240:255], v[140:143], v[52:55], v[240:255]
    v_and_b32 v19, 0xffff0000, v71
    v_fma_f32 v16, v16, v14, v12
    v_fma_f32 v18, v18, v14, v12
    ds_read_b64_tr_b16 v[116:117], v10 offset:7168
    ds_read_b64_tr_b16 v[118:119], v10 offset:8960
    s_waitcnt lgkmcnt(12)
    v_mfma_f32_32x32x16_bf16 v[144:159], v[88:91], v[56:59], v[144:159]
    v_fma_f32 v17, v17, v14, v12
    v_fma_f32 v19, v19, v14, v12
    ds_read_b64_tr_b16 v[120:121], v10 offset:7232
    ds_read_b64_tr_b16 v[122:123], v10 offset:9024
    v_mfma_f32_32x32x16_bf16 v[160:175], v[92:95], v[56:59], v[160:175]
    v_cvt_pk_bf16_f32 v70, v16, v17
    v_cvt_pk_bf16_f32 v71, v18, v19
    ds_read_b64_tr_b16 v[124:125], v10 offset:7296
    ds_read_b64_tr_b16 v[126:127], v10 offset:9088
    s_waitcnt lgkmcnt(12)
    v_mfma_f32_32x32x16_bf16 v[176:191], v[96:99], v[56:59], v[176:191]
    s_waitcnt vmcnt(3)
    v_lshlrev_b32 v16, 16, v72
    v_lshlrev_b32 v18, 16, v73
    ds_read_b64_tr_b16 v[128:129], v10 offset:7360
    ds_read_b64_tr_b16 v[130:131], v10 offset:9152
    v_mfma_f32_32x32x16_bf16 v[192:207], v[100:103], v[56:59], v[192:207]
    v_and_b32 v17, 0xffff0000, v72
    v_and_b32 v19, 0xffff0000, v73
    ds_read_b64_tr_b16 v[132:133], v10 offset:7424
    ds_read_b64_tr_b16 v[134:135], v10 offset:9216
    s_waitcnt lgkmcnt(12)
    v_mfma_f32_32x32x16_bf16 v[208:223], v[104:107], v[56:59], v[208:223]
    v_fma_f32 v16, v16, v14, v12
    v_fma_f32 v18, v18, v14, v12
    ds_read_b64_tr_b16 v[136:137], v10 offset:7488
    ds_read_b64_tr_b16 v[138:139], v10 offset:9280
    v_mfma_f32_32x32x16_bf16 v[224:239], v[108:111], v[56:59], v[224:239]
    v_fma_f32 v17, v17, v14, v12
    v_fma_f32 v19, v19, v14, v12
    ds_read_b64_tr_b16 v[140:141], v10 offset:7552
    ds_read_b64_tr_b16 v[142:143], v10 offset:9344
    s_waitcnt lgkmcnt(14)
    v_mfma_f32_32x32x16_bf16 v[240:255], v[112:115], v[56:59], v[240:255]
    v_cvt_pk_bf16_f32 v72, v16, v17
    v_cvt_pk_bf16_f32 v73, v18, v19
    s_barrier
    ds_read_b64_tr_b16 v[88:89], v8 offset:0
    ds_read_b64_tr_b16 v[90:91], v8 offset:1792
    s_waitcnt lgkmcnt(12)
    v_mfma_f32_32x32x16_bf16 v[144:159], v[116:119], v[60:63], v[144:159]
    v_lshlrev_b32 v16, 16, v74
    v_lshlrev_b32 v18, 16, v75
    ds_read_b64_tr_b16 v[92:93], v8 offset:64
    ds_read_b64_tr_b16 v[94:95], v8 offset:1856
    v_mfma_f32_32x32x16_bf16 v[160:175], v[120:123], v[60:63], v[160:175]
    v_and_b32 v17, 0xffff0000, v74
    v_and_b32 v19, 0xffff0000, v75
    ds_read_b64_tr_b16 v[96:97], v8 offset:128
    ds_read_b64_tr_b16 v[98:99], v8 offset:1920
    s_waitcnt lgkmcnt(12)
    v_mfma_f32_32x32x16_bf16 v[176:191], v[124:127], v[60:63], v[176:191]
    v_fma_f32 v16, v16, v14, v12
    v_fma_f32 v18, v18, v14, v12
    ds_read_b64_tr_b16 v[100:101], v8 offset:192
    ds_read_b64_tr_b16 v[102:103], v8 offset:1984
    v_mfma_f32_32x32x16_bf16 v[192:207], v[128:131], v[60:63], v[192:207]
    v_fma_f32 v17, v17, v14, v12
    v_fma_f32 v19, v19, v14, v12
    ds_read_b64_tr_b16 v[104:105], v8 offset:256
    ds_read_b64_tr_b16 v[106:107], v8 offset:2048
    s_waitcnt lgkmcnt(12)
    v_mfma_f32_32x32x16_bf16 v[208:223], v[132:135], v[60:63], v[208:223]
    v_cvt_pk_bf16_f32 v74, v16, v17
    v_cvt_pk_bf16_f32 v75, v18, v19
    ds_read_b64_tr_b16 v[108:109], v8 offset:320
    ds_read_b64_tr_b16 v[110:111], v8 offset:2112
    v_mfma_f32_32x32x16_bf16 v[224:239], v[136:139], v[60:63], v[224:239]
    s_waitcnt vmcnt(2)
    v_lshlrev_b32 v16, 16, v76
    v_lshlrev_b32 v18, 16, v77
    ds_read_b64_tr_b16 v[112:113], v8 offset:384
    ds_read_b64_tr_b16 v[114:115], v8 offset:2176
    s_waitcnt lgkmcnt(14)
    v_mfma_f32_32x32x16_bf16 v[240:255], v[140:143], v[60:63], v[240:255]
    v_and_b32 v17, 0xffff0000, v76
    v_and_b32 v19, 0xffff0000, v77
    ds_read_b64_tr_b16 v[116:117], v8 offset:7168
    ds_read_b64_tr_b16 v[118:119], v8 offset:8960
    s_waitcnt lgkmcnt(12)
    v_mfma_f32_32x32x16_bf16 v[144:159], v[88:91], v[64:67], v[144:159]
    v_fma_f32 v16, v16, v14, v12
    v_fma_f32 v18, v18, v14, v12
    ds_read_b64_tr_b16 v[120:121], v8 offset:7232
    ds_read_b64_tr_b16 v[122:123], v8 offset:9024
    v_mfma_f32_32x32x16_bf16 v[160:175], v[92:95], v[64:67], v[160:175]
    v_fma_f32 v17, v17, v14, v12
    v_fma_f32 v19, v19, v14, v12
    ds_read_b64_tr_b16 v[124:125], v8 offset:7296
    ds_read_b64_tr_b16 v[126:127], v8 offset:9088
    s_waitcnt lgkmcnt(12)
    v_mfma_f32_32x32x16_bf16 v[176:191], v[96:99], v[64:67], v[176:191]
    v_cvt_pk_bf16_f32 v76, v16, v17
    v_cvt_pk_bf16_f32 v77, v18, v19
    ds_read_b64_tr_b16 v[128:129], v8 offset:7360
    ds_read_b64_tr_b16 v[130:131], v8 offset:9152
    v_mfma_f32_32x32x16_bf16 v[192:207], v[100:103], v[64:67], v[192:207]
    v_lshlrev_b32 v16, 16, v78
    v_lshlrev_b32 v18, 16, v79
    ds_read_b64_tr_b16 v[132:133], v8 offset:7424
    ds_read_b64_tr_b16 v[134:135], v8 offset:9216
    s_waitcnt lgkmcnt(12)
    v_mfma_f32_32x32x16_bf16 v[208:223], v[104:107], v[64:67], v[208:223]
    v_and_b32 v17, 0xffff0000, v78
    v_and_b32 v19, 0xffff0000, v79
    ds_read_b64_tr_b16 v[136:137], v8 offset:7488
    ds_read_b64_tr_b16 v[138:139], v8 offset:9280
    v_mfma_f32_32x32x16_bf16 v[224:239], v[108:111], v[64:67], v[224:239]
    v_fma_f32 v16, v16, v14, v12
    v_fma_f32 v18, v18, v14, v12
    ds_read_b64_tr_b16 v[140:141], v8 offset:7552
    ds_read_b64_tr_b16 v[142:143], v8 offset:9344
    s_waitcnt lgkmcnt(14)
    v_mfma_f32_32x32x16_bf16 v[240:255], v[112:115], v[64:67], v[240:255]
    v_fma_f32 v17, v17, v14, v12
    v_fma_f32 v19, v19, v14, v12
    s_barrier
    ds_read_b64_tr_b16 v[88:89], v8 offset:28672
    ds_read_b64_tr_b16 v[90:91], v8 offset:30464
    s_waitcnt lgkmcnt(12)
    v_mfma_f32_32x32x16_bf16 v[144:159], v[116:119], v[68:71], v[144:159]
    v_cvt_pk_bf16_f32 v78, v16, v17
    v_cvt_pk_bf16_f32 v79, v18, v19
    ds_read_b64_tr_b16 v[92:93], v8 offset:28736
    ds_read_b64_tr_b16 v[94:95], v8 offset:30528
    v_mfma_f32_32x32x16_bf16 v[160:175], v[120:123], v[68:71], v[160:175]
    s_waitcnt vmcnt(1)
    v_lshlrev_b32 v16, 16, v80
    v_lshlrev_b32 v18, 16, v81
    ds_read_b64_tr_b16 v[96:97], v8 offset:28800
    ds_read_b64_tr_b16 v[98:99], v8 offset:30592
    s_waitcnt lgkmcnt(12)
    v_mfma_f32_32x32x16_bf16 v[176:191], v[124:127], v[68:71], v[176:191]
    v_and_b32 v17, 0xffff0000, v80
    v_and_b32 v19, 0xffff0000, v81
    ds_read_b64_tr_b16 v[100:101], v8 offset:28864
    ds_read_b64_tr_b16 v[102:103], v8 offset:30656
    v_mfma_f32_32x32x16_bf16 v[192:207], v[128:131], v[68:71], v[192:207]
    v_fma_f32 v16, v16, v14, v12
    v_fma_f32 v18, v18, v14, v12
    ds_read_b64_tr_b16 v[104:105], v8 offset:28928
    ds_read_b64_tr_b16 v[106:107], v8 offset:30720
    s_waitcnt lgkmcnt(12)
    v_mfma_f32_32x32x16_bf16 v[208:223], v[132:135], v[68:71], v[208:223]
    v_fma_f32 v17, v17, v14, v12
    v_fma_f32 v19, v19, v14, v12
    ds_read_b64_tr_b16 v[108:109], v8 offset:28992
    ds_read_b64_tr_b16 v[110:111], v8 offset:30784
    v_mfma_f32_32x32x16_bf16 v[224:239], v[136:139], v[68:71], v[224:239]
    v_cvt_pk_bf16_f32 v80, v16, v17
    v_cvt_pk_bf16_f32 v81, v18, v19
    ds_read_b64_tr_b16 v[112:113], v8 offset:29056
    ds_read_b64_tr_b16 v[114:115], v8 offset:30848
    s_waitcnt lgkmcnt(14)
    v_mfma_f32_32x32x16_bf16 v[240:255], v[140:143], v[68:71], v[240:255]
    v_lshlrev_b32 v16, 16, v82
    v_lshlrev_b32 v18, 16, v83
    ds_read_b64_tr_b16 v[116:117], v8 offset:35840
    ds_read_b64_tr_b16 v[118:119], v8 offset:37632
    s_waitcnt lgkmcnt(12)
    v_mfma_f32_32x32x16_bf16 v[144:159], v[88:91], v[72:75], v[144:159]
    v_and_b32 v17, 0xffff0000, v82
    v_and_b32 v19, 0xffff0000, v83
    ds_read_b64_tr_b16 v[120:121], v8 offset:35904
    ds_read_b64_tr_b16 v[122:123], v8 offset:37696
    v_mfma_f32_32x32x16_bf16 v[160:175], v[92:95], v[72:75], v[160:175]
    v_fma_f32 v16, v16, v14, v12
    v_fma_f32 v18, v18, v14, v12
    ds_read_b64_tr_b16 v[124:125], v8 offset:35968
    ds_read_b64_tr_b16 v[126:127], v8 offset:37760
    s_waitcnt lgkmcnt(12)
    v_mfma_f32_32x32x16_bf16 v[176:191], v[96:99], v[72:75], v[176:191]
    v_fma_f32 v17, v17, v14, v12
    v_fma_f32 v19, v19, v14, v12
    ds_read_b64_tr_b16 v[128:129], v8 offset:36032
    ds_read_b64_tr_b16 v[130:131], v8 offset:37824
    v_mfma_f32_32x32x16_bf16 v[192:207], v[100:103], v[72:75], v[192:207]
    v_cvt_pk_bf16_f32 v82, v16, v17
    v_cvt_pk_bf16_f32 v83, v18, v19
    ds_read_b64_tr_b16 v[132:133], v8 offset:36096
    ds_read_b64_tr_b16 v[134:135], v8 offset:37888
    s_waitcnt lgkmcnt(12)
    v_mfma_f32_32x32x16_bf16 v[208:223], v[104:107], v[72:75], v[208:223]
    s_waitcnt vmcnt(0)
    v_lshlrev_b32 v16, 16, v84
    v_lshlrev_b32 v18, 16, v85
    ds_read_b64_tr_b16 v[136:137], v8 offset:36160
    ds_read_b64_tr_b16 v[138:139], v8 offset:37952
    v_mfma_f32_32x32x16_bf16 v[224:239], v[108:111], v[72:75], v[224:239]
    v_and_b32 v17, 0xffff0000, v84
    v_and_b32 v19, 0xffff0000, v85
    ds_read_b64_tr_b16 v[140:141], v8 offset:36224
    ds_read_b64_tr_b16 v[142:143], v8 offset:38016
    s_waitcnt lgkmcnt(14)
    v_mfma_f32_32x32x16_bf16 v[240:255], v[112:115], v[72:75], v[240:255]
    v_fma_f32 v16, v16, v14, v12
    v_fma_f32 v18, v18, v14, v12
    s_barrier
    ds_read_b64_tr_b16 v[88:89], v9 offset:0
    ds_read_b64_tr_b16 v[90:91], v9 offset:1792
    s_waitcnt lgkmcnt(12)
    v_mfma_f32_32x32x16_bf16 v[144:159], v[116:119], v[76:79], v[144:159]
    v_fma_f32 v17, v17, v14, v12
    v_fma_f32 v19, v19, v14, v12
    ds_read_b64_tr_b16 v[92:93], v9 offset:64
    ds_read_b64_tr_b16 v[94:95], v9 offset:1856
    v_mfma_f32_32x32x16_bf16 v[160:175], v[120:123], v[76:79], v[160:175]
    v_cvt_pk_bf16_f32 v84, v16, v17
    v_cvt_pk_bf16_f32 v85, v18, v19
    ds_read_b64_tr_b16 v[96:97], v9 offset:128
    ds_read_b64_tr_b16 v[98:99], v9 offset:1920
    s_waitcnt lgkmcnt(12)
    v_mfma_f32_32x32x16_bf16 v[176:191], v[124:127], v[76:79], v[176:191]
    v_lshlrev_b32 v16, 16, v86
    v_lshlrev_b32 v18, 16, v87
    ds_read_b64_tr_b16 v[100:101], v9 offset:192
    ds_read_b64_tr_b16 v[102:103], v9 offset:1984
    v_mfma_f32_32x32x16_bf16 v[192:207], v[128:131], v[76:79], v[192:207]
    v_and_b32 v17, 0xffff0000, v86
    v_and_b32 v19, 0xffff0000, v87
    ds_read_b64_tr_b16 v[104:105], v9 offset:256
    ds_read_b64_tr_b16 v[106:107], v9 offset:2048
    s_waitcnt lgkmcnt(12)
    v_mfma_f32_32x32x16_bf16 v[208:223], v[132:135], v[76:79], v[208:223]
    v_fma_f32 v16, v16, v14, v12
    v_fma_f32 v18, v18, v14, v12
    ds_read_b64_tr_b16 v[108:109], v9 offset:320
    ds_read_b64_tr_b16 v[110:111], v9 offset:2112
    v_mfma_f32_32x32x16_bf16 v[224:239], v[136:139], v[76:79], v[224:239]
    v_fma_f32 v17, v17, v14, v12
    v_fma_f32 v19, v19, v14, v12
    ds_read_b64_tr_b16 v[112:113], v9 offset:384
    ds_read_b64_tr_b16 v[114:115], v9 offset:2176
    s_waitcnt lgkmcnt(14)
    v_mfma_f32_32x32x16_bf16 v[240:255], v[140:143], v[76:79], v[240:255]
    v_cvt_pk_bf16_f32 v86, v16, v17
    v_cvt_pk_bf16_f32 v87, v18, v19
    ds_read_b64_tr_b16 v[116:117], v9 offset:7168
    ds_read_b64_tr_b16 v[118:119], v9 offset:8960
    s_waitcnt lgkmcnt(12)
    v_mfma_f32_32x32x16_bf16 v[144:159], v[88:91], v[80:83], v[144:159]
    ds_read_b64_tr_b16 v[120:121], v9 offset:7232
    ds_read_b64_tr_b16 v[122:123], v9 offset:9024
    v_mfma_f32_32x32x16_bf16 v[160:175], v[92:95], v[80:83], v[160:175]
    ds_read_b64_tr_b16 v[124:125], v9 offset:7296
    ds_read_b64_tr_b16 v[126:127], v9 offset:9088
    s_waitcnt lgkmcnt(12)
    v_mfma_f32_32x32x16_bf16 v[176:191], v[96:99], v[80:83], v[176:191]
    ds_read_b64_tr_b16 v[128:129], v9 offset:7360
    ds_read_b64_tr_b16 v[130:131], v9 offset:9152
    v_mfma_f32_32x32x16_bf16 v[192:207], v[100:103], v[80:83], v[192:207]
    ds_read_b64_tr_b16 v[132:133], v9 offset:7424
    ds_read_b64_tr_b16 v[134:135], v9 offset:9216
    s_waitcnt lgkmcnt(12)
    v_mfma_f32_32x32x16_bf16 v[208:223], v[104:107], v[80:83], v[208:223]
    ds_read_b64_tr_b16 v[136:137], v9 offset:7488
    ds_read_b64_tr_b16 v[138:139], v9 offset:9280
    v_mfma_f32_32x32x16_bf16 v[224:239], v[108:111], v[80:83], v[224:239]
    ds_read_b64_tr_b16 v[140:141], v9 offset:7552
    ds_read_b64_tr_b16 v[142:143], v9 offset:9344
    s_waitcnt lgkmcnt(14)
    v_mfma_f32_32x32x16_bf16 v[240:255], v[112:115], v[80:83], v[240:255]
    s_waitcnt lgkmcnt(10)
    v_mfma_f32_32x32x16_bf16 v[144:159], v[116:119], v[84:87], v[144:159]
    v_mfma_f32_32x32x16_bf16 v[160:175], v[120:123], v[84:87], v[160:175]
    s_waitcnt lgkmcnt(6)
    v_mfma_f32_32x32x16_bf16 v[176:191], v[124:127], v[84:87], v[176:191]
    v_mfma_f32_32x32x16_bf16 v[192:207], v[128:131], v[84:87], v[192:207]
    s_waitcnt lgkmcnt(2)
    v_mfma_f32_32x32x16_bf16 v[208:223], v[132:135], v[84:87], v[208:223]
    v_mfma_f32_32x32x16_bf16 v[224:239], v[136:139], v[84:87], v[224:239]
    s_waitcnt lgkmcnt(0)
    v_mfma_f32_32x32x16_bf16 v[240:255], v[140:143], v[84:87], v[240:255]
    s_barrier
    v_mov_b32 v12, 1
    v_mov_b32 v16, 0xc0135761
    v_mov_b32 v17, 0xc0135761
    v_mov_b32 v18, 0xbdd2d3e8
    v_mov_b32 v19, 0xbdd2d3e8
    v_mov_b32 v20, 1.0
    v_mov_b32 v21, 1.0

    ds_write_b128 v6, v[152:155] offset:0
    ds_write_b128 v6, v[156:159] offset:1024
    ds_write_b128 v6, v[168:171] offset:2048
    ds_write_b128 v6, v[172:175] offset:3072
    ds_write_b128 v6, v[184:187] offset:4096
    ds_write_b128 v6, v[188:191] offset:5120
    ds_write_b128 v6, v[200:203] offset:6144
    ds_write_b128 v6, v[204:207] offset:7168
    ds_write_b128 v6, v[216:219] offset:8192
    ds_write_b128 v6, v[220:223] offset:9216
    ds_write_b128 v6, v[232:235] offset:10240
    ds_write_b128 v6, v[236:239] offset:11264
    ds_write_b128 v6, v[248:251] offset:12288
    ds_write_b128 v6, v[252:255] offset:13312
    ds_write_b32 v11, v12
    v_xor_b32 v11, 8, v11
L_mid_x:
    ds_read_b32 v13, v11 offset:0
    s_waitcnt lgkmcnt(0)
    v_readfirstlane_b32 s45, v13
    s_cmp_ge_u32 s45, 1
    s_cbranch_scc1 L_mid_x_ok
    s_sleep 1
    s_branch L_mid_x
L_mid_x_ok:
    ds_read_b128 v[152:155], v7 offset:0
    ds_read_b128 v[156:159], v7 offset:1024
    ds_read_b128 v[168:171], v7 offset:2048
    ds_read_b128 v[172:175], v7 offset:3072
    ds_read_b128 v[184:187], v7 offset:4096
    ds_read_b128 v[188:191], v7 offset:5120
    ds_read_b128 v[200:203], v7 offset:6144
    ds_read_b128 v[204:207], v7 offset:7168
    ds_read_b128 v[216:219], v7 offset:8192
    ds_read_b128 v[220:223], v7 offset:9216
    ds_read_b128 v[232:235], v7 offset:10240
    ds_read_b128 v[236:239], v7 offset:11264
    ds_read_b128 v[248:251], v7 offset:12288
    ds_read_b128 v[252:255], v7 offset:13312
    s_waitcnt lgkmcnt(12)
    v_pk_add_f32 v[144:145], v[144:145], v[152:153]
    v_pk_add_f32 v[146:147], v[146:147], v[154:155]
    v_pk_add_f32 v[148:149], v[148:149], v[156:157]
    v_pk_add_f32 v[150:151], v[150:151], v[158:159]
    v_pk_mul_f32 v[152:153], v[144:145], v[144:145]
    v_pk_mul_f32 v[154:155], v[146:147], v[146:147]
    v_pk_mul_f32 v[156:157], v[148:149], v[148:149]
    v_pk_mul_f32 v[158:159], v[150:151], v[150:151]
    v_pk_fma_f32 v[152:153], v[152:153], v[18:19], v[16:17]
    v_pk_fma_f32 v[154:155], v[154:155], v[18:19], v[16:17]
    v_pk_fma_f32 v[156:157], v[156:157], v[18:19], v[16:17]
    v_pk_fma_f32 v[158:159], v[158:159], v[18:19], v[16:17]
    v_pk_mul_f32 v[152:153], v[152:153], v[144:145]
    v_pk_mul_f32 v[154:155], v[154:155], v[146:147]
    v_pk_mul_f32 v[156:157], v[156:157], v[148:149]
    v_pk_mul_f32 v[158:159], v[158:159], v[150:151]
    v_exp_f32 v152, v152
    v_exp_f32 v153, v153
    v_exp_f32 v154, v154
    v_exp_f32 v155, v155
    v_exp_f32 v156, v156
    v_exp_f32 v157, v157
    v_exp_f32 v158, v158
    v_exp_f32 v159, v159
    v_pk_add_f32 v[152:153], v[152:153], v[20:21]
    v_pk_add_f32 v[154:155], v[154:155], v[20:21]
    v_pk_add_f32 v[156:157], v[156:157], v[20:21]
    v_pk_add_f32 v[158:159], v[158:159], v[20:21]
    v_rcp_f32 v152, v152
    v_rcp_f32 v153, v153
    v_rcp_f32 v154, v154
    v_rcp_f32 v155, v155
    v_rcp_f32 v156, v156
    v_rcp_f32 v157, v157
    v_rcp_f32 v158, v158
    v_rcp_f32 v159, v159
    v_pk_mul_f32 v[144:145], v[144:145], v[152:153]
    v_pk_mul_f32 v[146:147], v[146:147], v[154:155]
    v_pk_mul_f32 v[148:149], v[148:149], v[156:157]
    v_pk_mul_f32 v[150:151], v[150:151], v[158:159]
    v_cvt_pk_bf16_f32 v152, v144, v145
    v_cvt_pk_bf16_f32 v153, v146, v147
    v_cvt_pk_bf16_f32 v154, v148, v149
    v_cvt_pk_bf16_f32 v155, v150, v151
    s_add_u32 s41, s40, 0
    buffer_store_dwordx4 v[152:155], v2, s[16:19], s41 offen sc0 sc1
    s_waitcnt lgkmcnt(10)
    v_pk_add_f32 v[160:161], v[160:161], v[168:169]
    v_pk_add_f32 v[162:163], v[162:163], v[170:171]
    v_pk_add_f32 v[164:165], v[164:165], v[172:173]
    v_pk_add_f32 v[166:167], v[166:167], v[174:175]
    v_pk_mul_f32 v[168:169], v[160:161], v[160:161]
    v_pk_mul_f32 v[170:171], v[162:163], v[162:163]
    v_pk_mul_f32 v[172:173], v[164:165], v[164:165]
    v_pk_mul_f32 v[174:175], v[166:167], v[166:167]
    v_pk_fma_f32 v[168:169], v[168:169], v[18:19], v[16:17]
    v_pk_fma_f32 v[170:171], v[170:171], v[18:19], v[16:17]
    v_pk_fma_f32 v[172:173], v[172:173], v[18:19], v[16:17]
    v_pk_fma_f32 v[174:175], v[174:175], v[18:19], v[16:17]
    v_pk_mul_f32 v[168:169], v[168:169], v[160:161]
    v_pk_mul_f32 v[170:171], v[170:171], v[162:163]
    v_pk_mul_f32 v[172:173], v[172:173], v[164:165]
    v_pk_mul_f32 v[174:175], v[174:175], v[166:167]
    v_exp_f32 v168, v168
    v_exp_f32 v169, v169
    v_exp_f32 v170, v170
    v_exp_f32 v171, v171
    v_exp_f32 v172, v172
    v_exp_f32 v173, v173
    v_exp_f32 v174, v174
    v_exp_f32 v175, v175
    v_pk_add_f32 v[168:169], v[168:169], v[20:21]
    v_pk_add_f32 v[170:171], v[170:171], v[20:21]
    v_pk_add_f32 v[172:173], v[172:173], v[20:21]
    v_pk_add_f32 v[174:175], v[174:175], v[20:21]
    v_rcp_f32 v168, v168
    v_rcp_f32 v169, v169
    v_rcp_f32 v170, v170
    v_rcp_f32 v171, v171
    v_rcp_f32 v172, v172
    v_rcp_f32 v173, v173
    v_rcp_f32 v174, v174
    v_rcp_f32 v175, v175
    v_pk_mul_f32 v[160:161], v[160:161], v[168:169]
    v_pk_mul_f32 v[162:163], v[162:163], v[170:171]
    v_pk_mul_f32 v[164:165], v[164:165], v[172:173]
    v_pk_mul_f32 v[166:167], v[166:167], v[174:175]
    v_cvt_pk_bf16_f32 v168, v160, v161
    v_cvt_pk_bf16_f32 v169, v162, v163
    v_cvt_pk_bf16_f32 v170, v164, v165
    v_cvt_pk_bf16_f32 v171, v166, v167
    s_add_u32 s41, s40, 4096
    buffer_store_dwordx4 v[168:171], v2, s[16:19], s41 offen sc0 sc1
    s_waitcnt lgkmcnt(8)
    v_pk_add_f32 v[176:177], v[176:177], v[184:185]
    v_pk_add_f32 v[178:179], v[178:179], v[186:187]
    v_pk_add_f32 v[180:181], v[180:181], v[188:189]
    v_pk_add_f32 v[182:183], v[182:183], v[190:191]
    v_pk_mul_f32 v[184:185], v[176:177], v[176:177]
    v_pk_mul_f32 v[186:187], v[178:179], v[178:179]
    v_pk_mul_f32 v[188:189], v[180:181], v[180:181]
    v_pk_mul_f32 v[190:191], v[182:183], v[182:183]
    v_pk_fma_f32 v[184:185], v[184:185], v[18:19], v[16:17]
    v_pk_fma_f32 v[186:187], v[186:187], v[18:19], v[16:17]
    v_pk_fma_f32 v[188:189], v[188:189], v[18:19], v[16:17]
    v_pk_fma_f32 v[190:191], v[190:191], v[18:19], v[16:17]
    v_pk_mul_f32 v[184:185], v[184:185], v[176:177]
    v_pk_mul_f32 v[186:187], v[186:187], v[178:179]
    v_pk_mul_f32 v[188:189], v[188:189], v[180:181]
    v_pk_mul_f32 v[190:191], v[190:191], v[182:183]
    v_exp_f32 v184, v184
    v_exp_f32 v185, v185
    v_exp_f32 v186, v186
    v_exp_f32 v187, v187
    v_exp_f32 v188, v188
    v_exp_f32 v189, v189
    v_exp_f32 v190, v190
    v_exp_f32 v191, v191
    v_pk_add_f32 v[184:185], v[184:185], v[20:21]
    v_pk_add_f32 v[186:187], v[186:187], v[20:21]
    v_pk_add_f32 v[188:189], v[188:189], v[20:21]
    v_pk_add_f32 v[190:191], v[190:191], v[20:21]
    v_rcp_f32 v184, v184
    v_rcp_f32 v185, v185
    v_rcp_f32 v186, v186
    v_rcp_f32 v187, v187
    v_rcp_f32 v188, v188
    v_rcp_f32 v189, v189
    v_rcp_f32 v190, v190
    v_rcp_f32 v191, v191
    v_pk_mul_f32 v[176:177], v[176:177], v[184:185]
    v_pk_mul_f32 v[178:179], v[178:179], v[186:187]
    v_pk_mul_f32 v[180:181], v[180:181], v[188:189]
    v_pk_mul_f32 v[182:183], v[182:183], v[190:191]
    v_cvt_pk_bf16_f32 v184, v176, v177
    v_cvt_pk_bf16_f32 v185, v178, v179
    v_cvt_pk_bf16_f32 v186, v180, v181
    v_cvt_pk_bf16_f32 v187, v182, v183
    s_add_u32 s41, s40, 8192
    buffer_store_dwordx4 v[184:187], v2, s[16:19], s41 offen sc0 sc1
    s_waitcnt lgkmcnt(6)
    v_pk_add_f32 v[192:193], v[192:193], v[200:201]
    v_pk_add_f32 v[194:195], v[194:195], v[202:203]
    v_pk_add_f32 v[196:197], v[196:197], v[204:205]
    v_pk_add_f32 v[198:199], v[198:199], v[206:207]
    v_pk_mul_f32 v[200:201], v[192:193], v[192:193]
    v_pk_mul_f32 v[202:203], v[194:195], v[194:195]
    v_pk_mul_f32 v[204:205], v[196:197], v[196:197]
    v_pk_mul_f32 v[206:207], v[198:199], v[198:199]
    v_pk_fma_f32 v[200:201], v[200:201], v[18:19], v[16:17]
    v_pk_fma_f32 v[202:203], v[202:203], v[18:19], v[16:17]
    v_pk_fma_f32 v[204:205], v[204:205], v[18:19], v[16:17]
    v_pk_fma_f32 v[206:207], v[206:207], v[18:19], v[16:17]
    v_pk_mul_f32 v[200:201], v[200:201], v[192:193]
    v_pk_mul_f32 v[202:203], v[202:203], v[194:195]
    v_pk_mul_f32 v[204:205], v[204:205], v[196:197]
    v_pk_mul_f32 v[206:207], v[206:207], v[198:199]
    v_exp_f32 v200, v200
    v_exp_f32 v201, v201
    v_exp_f32 v202, v202
    v_exp_f32 v203, v203
    v_exp_f32 v204, v204
    v_exp_f32 v205, v205
    v_exp_f32 v206, v206
    v_exp_f32 v207, v207
    v_pk_add_f32 v[200:201], v[200:201], v[20:21]
    v_pk_add_f32 v[202:203], v[202:203], v[20:21]
    v_pk_add_f32 v[204:205], v[204:205], v[20:21]
    v_pk_add_f32 v[206:207], v[206:207], v[20:21]
    v_rcp_f32 v200, v200
    v_rcp_f32 v201, v201
    v_rcp_f32 v202, v202
    v_rcp_f32 v203, v203
    v_rcp_f32 v204, v204
    v_rcp_f32 v205, v205
    v_rcp_f32 v206, v206
    v_rcp_f32 v207, v207
    v_pk_mul_f32 v[192:193], v[192:193], v[200:201]
    v_pk_mul_f32 v[194:195], v[194:195], v[202:203]
    v_pk_mul_f32 v[196:197], v[196:197], v[204:205]
    v_pk_mul_f32 v[198:199], v[198:199], v[206:207]
    v_cvt_pk_bf16_f32 v200, v192, v193
    v_cvt_pk_bf16_f32 v201, v194, v195
    v_cvt_pk_bf16_f32 v202, v196, v197
    v_cvt_pk_bf16_f32 v203, v198, v199
    s_add_u32 s41, s40, 12288
    buffer_store_dwordx4 v[200:203], v2, s[16:19], s41 offen sc0 sc1
    s_waitcnt lgkmcnt(4)
    v_pk_add_f32 v[208:209], v[208:209], v[216:217]
    v_pk_add_f32 v[210:211], v[210:211], v[218:219]
    v_pk_add_f32 v[212:213], v[212:213], v[220:221]
    v_pk_add_f32 v[214:215], v[214:215], v[222:223]
    v_pk_mul_f32 v[216:217], v[208:209], v[208:209]
    v_pk_mul_f32 v[218:219], v[210:211], v[210:211]
    v_pk_mul_f32 v[220:221], v[212:213], v[212:213]
    v_pk_mul_f32 v[222:223], v[214:215], v[214:215]
    v_pk_fma_f32 v[216:217], v[216:217], v[18:19], v[16:17]
    v_pk_fma_f32 v[218:219], v[218:219], v[18:19], v[16:17]
    v_pk_fma_f32 v[220:221], v[220:221], v[18:19], v[16:17]
    v_pk_fma_f32 v[222:223], v[222:223], v[18:19], v[16:17]
    v_pk_mul_f32 v[216:217], v[216:217], v[208:209]
    v_pk_mul_f32 v[218:219], v[218:219], v[210:211]
    v_pk_mul_f32 v[220:221], v[220:221], v[212:213]
    v_pk_mul_f32 v[222:223], v[222:223], v[214:215]
    v_exp_f32 v216, v216
    v_exp_f32 v217, v217
    v_exp_f32 v218, v218
    v_exp_f32 v219, v219
    v_exp_f32 v220, v220
    v_exp_f32 v221, v221
    v_exp_f32 v222, v222
    v_exp_f32 v223, v223
    v_pk_add_f32 v[216:217], v[216:217], v[20:21]
    v_pk_add_f32 v[218:219], v[218:219], v[20:21]
    v_pk_add_f32 v[220:221], v[220:221], v[20:21]
    v_pk_add_f32 v[222:223], v[222:223], v[20:21]
    v_rcp_f32 v216, v216
    v_rcp_f32 v217, v217
    v_rcp_f32 v218, v218
    v_rcp_f32 v219, v219
    v_rcp_f32 v220, v220
    v_rcp_f32 v221, v221
    v_rcp_f32 v222, v222
    v_rcp_f32 v223, v223
    v_pk_mul_f32 v[208:209], v[208:209], v[216:217]
    v_pk_mul_f32 v[210:211], v[210:211], v[218:219]
    v_pk_mul_f32 v[212:213], v[212:213], v[220:221]
    v_pk_mul_f32 v[214:215], v[214:215], v[222:223]
    v_cvt_pk_bf16_f32 v216, v208, v209
    v_cvt_pk_bf16_f32 v217, v210, v211
    v_cvt_pk_bf16_f32 v218, v212, v213
    v_cvt_pk_bf16_f32 v219, v214, v215
    s_add_u32 s41, s40, 16384
    buffer_store_dwordx4 v[216:219], v2, s[16:19], s41 offen sc0 sc1
    s_waitcnt lgkmcnt(2)
    v_pk_add_f32 v[224:225], v[224:225], v[232:233]
    v_pk_add_f32 v[226:227], v[226:227], v[234:235]
    v_pk_add_f32 v[228:229], v[228:229], v[236:237]
    v_pk_add_f32 v[230:231], v[230:231], v[238:239]
    v_pk_mul_f32 v[232:233], v[224:225], v[224:225]
    v_pk_mul_f32 v[234:235], v[226:227], v[226:227]
    v_pk_mul_f32 v[236:237], v[228:229], v[228:229]
    v_pk_mul_f32 v[238:239], v[230:231], v[230:231]
    v_pk_fma_f32 v[232:233], v[232:233], v[18:19], v[16:17]
    v_pk_fma_f32 v[234:235], v[234:235], v[18:19], v[16:17]
    v_pk_fma_f32 v[236:237], v[236:237], v[18:19], v[16:17]
    v_pk_fma_f32 v[238:239], v[238:239], v[18:19], v[16:17]
    v_pk_mul_f32 v[232:233], v[232:233], v[224:225]
    v_pk_mul_f32 v[234:235], v[234:235], v[226:227]
    v_pk_mul_f32 v[236:237], v[236:237], v[228:229]
    v_pk_mul_f32 v[238:239], v[238:239], v[230:231]
    v_exp_f32 v232, v232
    v_exp_f32 v233, v233
    v_exp_f32 v234, v234
    v_exp_f32 v235, v235
    v_exp_f32 v236, v236
    v_exp_f32 v237, v237
    v_exp_f32 v238, v238
    v_exp_f32 v239, v239
    v_pk_add_f32 v[232:233], v[232:233], v[20:21]
    v_pk_add_f32 v[234:235], v[234:235], v[20:21]
    v_pk_add_f32 v[236:237], v[236:237], v[20:21]
    v_pk_add_f32 v[238:239], v[238:239], v[20:21]
    v_rcp_f32 v232, v232
    v_rcp_f32 v233, v233
    v_rcp_f32 v234, v234
    v_rcp_f32 v235, v235
    v_rcp_f32 v236, v236
    v_rcp_f32 v237, v237
    v_rcp_f32 v238, v238
    v_rcp_f32 v239, v239
    v_pk_mul_f32 v[224:225], v[224:225], v[232:233]
    v_pk_mul_f32 v[226:227], v[226:227], v[234:235]
    v_pk_mul_f32 v[228:229], v[228:229], v[236:237]
    v_pk_mul_f32 v[230:231], v[230:231], v[238:239]
    v_cvt_pk_bf16_f32 v232, v224, v225
    v_cvt_pk_bf16_f32 v233, v226, v227
    v_cvt_pk_bf16_f32 v234, v228, v229
    v_cvt_pk_bf16_f32 v235, v230, v231
    s_add_u32 s41, s40, 20480
    buffer_store_dwordx4 v[232:235], v2, s[16:19], s41 offen sc0 sc1
    s_waitcnt lgkmcnt(0)
    v_pk_add_f32 v[240:241], v[240:241], v[248:249]
    v_pk_add_f32 v[242:243], v[242:243], v[250:251]
    v_pk_add_f32 v[244:245], v[244:245], v[252:253]
    v_pk_add_f32 v[246:247], v[246:247], v[254:255]
    v_pk_mul_f32 v[248:249], v[240:241], v[240:241]
    v_pk_mul_f32 v[250:251], v[242:243], v[242:243]
    v_pk_mul_f32 v[252:253], v[244:245], v[244:245]
    v_pk_mul_f32 v[254:255], v[246:247], v[246:247]
    v_pk_fma_f32 v[248:249], v[248:249], v[18:19], v[16:17]
    v_pk_fma_f32 v[250:251], v[250:251], v[18:19], v[16:17]
    v_pk_fma_f32 v[252:253], v[252:253], v[18:19], v[16:17]
    v_pk_fma_f32 v[254:255], v[254:255], v[18:19], v[16:17]
    v_pk_mul_f32 v[248:249], v[248:249], v[240:241]
    v_pk_mul_f32 v[250:251], v[250:251], v[242:243]
    v_pk_mul_f32 v[252:253], v[252:253], v[244:245]
    v_pk_mul_f32 v[254:255], v[254:255], v[246:247]
    v_exp_f32 v248, v248
    v_exp_f32 v249, v249
    v_exp_f32 v250, v250
    v_exp_f32 v251, v251
    v_exp_f32 v252, v252
    v_exp_f32 v253, v253
    v_exp_f32 v254, v254
    v_exp_f32 v255, v255
    v_pk_add_f32 v[248:249], v[248:249], v[20:21]
    v_pk_add_f32 v[250:251], v[250:251], v[20:21]
    v_pk_add_f32 v[252:253], v[252:253], v[20:21]
    v_pk_add_f32 v[254:255], v[254:255], v[20:21]
    v_rcp_f32 v248, v248
    v_rcp_f32 v249, v249
    v_rcp_f32 v250, v250
    v_rcp_f32 v251, v251
    v_rcp_f32 v252, v252
    v_rcp_f32 v253, v253
    v_rcp_f32 v254, v254
    v_rcp_f32 v255, v255
    v_pk_mul_f32 v[240:241], v[240:241], v[248:249]
    v_pk_mul_f32 v[242:243], v[242:243], v[250:251]
    v_pk_mul_f32 v[244:245], v[244:245], v[252:253]
    v_pk_mul_f32 v[246:247], v[246:247], v[254:255]
    v_cvt_pk_bf16_f32 v248, v240, v241
    v_cvt_pk_bf16_f32 v249, v242, v243
    v_cvt_pk_bf16_f32 v250, v244, v245
    v_cvt_pk_bf16_f32 v251, v246, v247
    s_add_u32 s41, s40, 24576
    buffer_store_dwordx4 v[248:251], v2, s[16:19], s41 offen sc0 sc1
    s_lshr_b32 s34, s26, 1
    s_and_b32 s35, s26, 1
    s_lshl_b32 s36, s34, 10
    s_add_u32 s36, s36, 81920
    v_add_u32 v6, s36, v2
    v_and_b32 v12, 31, v1
    v_lshrrev_b32 v13, 5, v1
    s_lshl_b32 s36, s35, 6

    v_and_b32 v14, 1, v1
    v_lshlrev_b32 v14, 4, v14
    v_bfe_u32 v15, v1, 1, 1
    v_lshl_or_b32 v14, v15, 3, v14
    v_bfe_u32 v15, v1, 4, 1
    v_lshl_or_b32 v14, v15, 5, v14

    v_lshlrev_b32 v7, 3, v13
    v_bfe_u32 v15, v1, 2, 2
    v_add_u32 v7, v7, v15
    v_lshlrev_b32 v7, 7, v7
    v_lshrrev_b32 v15, 1, v15
    v_lshlrev_b32 v15, 6, v15
    v_xor_b32 v14, v14, v15
    v_xor_b32 v14, s36, v14
    v_add_u32 v7, v7, v14
    v_add_u32 v8, 49152, v6
    v_add_u32 v9, 49152, v7
    s_lshl_b32 s36, s27, 1
    s_add_u32 s36, s36, s34
    s_lshl_b32 s36, s36, 15
    s_lshl_b32 s37, s28, 1
    s_add_u32 s37, s37, s35
    s_lshl_b32 s38, s37, 12
    s_lshl_b32 s37, s37, 6
    s_add_u32 s36, s36, s37
    s_lshl_b32 s39, s27, 16
    s_add_u32 s38, s38, s39
    s_lshl_b32 s39, s34, 10
    s_add_u32 s38, s38, s39
    s_add_u32 s38, s38, 8388608
    v_lshlrev_b32 v5, 10, v12
    v_lshl_or_b32 v5, v13, 4, v5
    v_lshlrev_b32 v3, 4, v13
    v_mov_b32 v15, 1
    v_mov_b32 v16, 0
    s_add_u32 s44, s44, 4096
    s_waitcnt vmcnt(0)
    s_barrier
    s_mov_b64 exec, 1
    s_cmp_lg_u32 s26, 0
    s_cbranch_scc1 L_mid_nosig2
    buffer_atomic_add v15, v16, s[16:19], s44 offen sc1

L_mid_nosig2:
    s_mov_b64 exec, -1
    ds_read_b64_tr_b16 v[128:129], v7 offset:0
    ds_read_b64_tr_b16 v[130:131], v7 offset:512
    ds_read_b64_tr_b16 v[132:133], v7 offset:2048
    ds_read_b64_tr_b16 v[134:135], v7 offset:2560
    ds_read_b64_tr_b16 v[136:137], v7 offset:4096
    ds_read_b64_tr_b16 v[138:139], v7 offset:4608
    ds_read_b64_tr_b16 v[140:141], v7 offset:6144
    ds_read_b64_tr_b16 v[142:143], v7 offset:6656
    ds_read_b64_tr_b16 v[144:145], v7 offset:8192
    ds_read_b64_tr_b16 v[146:147], v7 offset:8704
    ds_read_b64_tr_b16 v[148:149], v7 offset:10240
    ds_read_b64_tr_b16 v[150:151], v7 offset:10752
    ds_read_b64_tr_b16 v[152:153], v7 offset:12288
    ds_read_b64_tr_b16 v[154:155], v7 offset:12800
    ds_read_b64_tr_b16 v[156:157], v7 offset:14336
    ds_read_b64_tr_b16 v[158:159], v7 offset:14848
    ds_read_b64_tr_b16 v[160:161], v7 offset:16384
    ds_read_b64_tr_b16 v[162:163], v7 offset:16896
    ds_read_b64_tr_b16 v[164:165], v7 offset:18432
    ds_read_b64_tr_b16 v[166:167], v7 offset:18944
    ds_read_b64_tr_b16 v[168:169], v7 offset:20480
    ds_read_b64_tr_b16 v[170:171], v7 offset:20992
    ds_read_b64_tr_b16 v[172:173], v7 offset:22528
    ds_read_b64_tr_b16 v[174:175], v7 offset:23040
    ds_read_b64_tr_b16 v[176:177], v7 offset:24576
    ds_read_b64_tr_b16 v[178:179], v7 offset:25088
    ds_read_b64_tr_b16 v[180:181], v7 offset:26624
    ds_read_b64_tr_b16 v[182:183], v7 offset:27136
    ds_read_b64_tr_b16 v[184:185], v7 offset:28672
    ds_read_b64_tr_b16 v[186:187], v7 offset:29184
    ds_read_b64_tr_b16 v[188:189], v7 offset:30720
    ds_read_b64_tr_b16 v[190:191], v7 offset:31232
    ds_read_b64_tr_b16 v[192:193], v7 offset:32768
    ds_read_b64_tr_b16 v[194:195], v7 offset:33280
    ds_read_b64_tr_b16 v[196:197], v7 offset:34816
    ds_read_b64_tr_b16 v[198:199], v7 offset:35328
    ds_read_b64_tr_b16 v[200:201], v7 offset:36864
    ds_read_b64_tr_b16 v[202:203], v7 offset:37376
    ds_read_b64_tr_b16 v[204:205], v7 offset:38912
    ds_read_b64_tr_b16 v[206:207], v7 offset:39424
    ds_read_b64_tr_b16 v[208:209], v7 offset:40960
    ds_read_b64_tr_b16 v[210:211], v7 offset:41472
    ds_read_b64_tr_b16 v[212:213], v7 offset:43008
    ds_read_b64_tr_b16 v[214:215], v7 offset:43520
    ds_read_b64_tr_b16 v[216:217], v7 offset:45056
    ds_read_b64_tr_b16 v[218:219], v7 offset:45568
    ds_read_b64_tr_b16 v[220:221], v7 offset:47104
    ds_read_b64_tr_b16 v[222:223], v7 offset:47616
    ds_read_b64_tr_b16 v[224:225], v9 offset:0
    ds_read_b64_tr_b16 v[226:227], v9 offset:512
    ds_read_b64_tr_b16 v[228:229], v9 offset:2048
    ds_read_b64_tr_b16 v[230:231], v9 offset:2560
    ds_read_b64_tr_b16 v[232:233], v9 offset:4096
    ds_read_b64_tr_b16 v[234:235], v9 offset:4608
    ds_read_b64_tr_b16 v[236:237], v9 offset:6144
    ds_read_b64_tr_b16 v[238:239], v9 offset:6656
    ds_read_b64_tr_b16 v[240:241], v9 offset:8192
    ds_read_b64_tr_b16 v[242:243], v9 offset:8704
    ds_read_b64_tr_b16 v[244:245], v9 offset:10240
    ds_read_b64_tr_b16 v[246:247], v9 offset:10752
    ds_read_b64_tr_b16 v[248:249], v9 offset:12288
    ds_read_b64_tr_b16 v[250:251], v9 offset:12800
    ds_read_b64_tr_b16 v[252:253], v9 offset:14336
    ds_read_b64_tr_b16 v[254:255], v9 offset:14848
    s_waitcnt lgkmcnt(0)
    s_barrier
    s_cmp_lg_u32 s26, 0
    s_cbranch_scc1 L_mid_go2
    s_mov_b32 s47, 0
L_mid_poll2:
    buffer_load_dword v17, v16, s[16:19], s44 offen sc1
    s_waitcnt vmcnt(0)
    v_readfirstlane_b32 s45, v17
    s_cmp_ge_u32 s45, 8
    s_cbranch_scc1 L_mid_go2
    s_add_u32 s47, s47, 1
    s_cmp_gt_u32 s47, 0x200000
    s_cbranch_scc1 L_mid_go2
    s_sleep 2
    s_branch L_mid_poll2

L_mid_go2:
    s_barrier
    s_mov_b32 s12, s60
    s_mov_b32 s13, s61
    s_mov_b32 s14, 1024
    s_mov_b32 s15, 0x00020000
    s_mov_b32 s8, s62
    s_mov_b32 s9, s63
    s_mov_b32 s10, 2097152
    s_mov_b32 s11, 0x00020000
    buffer_load_dwordx4 v[112:115], v2, s[16:19], s38 offen sc1
    buffer_load_dwordx4 v[116:119], v2, s[16:19], s38 offen offset:2048 sc1
    buffer_load_dwordx4 v[120:123], v3, s[12:15], s37 offen
    buffer_load_dwordx4 v[124:127], v3, s[12:15], s37 offen offset:32
    v_mov_b32 v80, 0
    v_mov_b32 v81, 0
    v_mov_b32 v82, 0
    v_mov_b32 v83, 0
    v_mov_b32 v84, 0
    v_mov_b32 v85, 0
    v_mov_b32 v86, 0
    v_mov_b32 v87, 0
    v_mov_b32 v88, 0
    v_mov_b32 v89, 0
    v_mov_b32 v90, 0
    v_mov_b32 v91, 0
    v_mov_b32 v92, 0
    v_mov_b32 v93, 0
    v_mov_b32 v94, 0
    v_mov_b32 v95, 0
    v_mov_b32 v96, 0
    v_mov_b32 v97, 0
    v_mov_b32 v98, 0
    v_mov_b32 v99, 0
    v_mov_b32 v100, 0
    v_mov_b32 v101, 0
    v_mov_b32 v102, 0
    v_mov_b32 v103, 0
    v_mov_b32 v104, 0
    v_mov_b32 v105, 0
    v_mov_b32 v106, 0
    v_mov_b32 v107, 0
    v_mov_b32 v108, 0
    v_mov_b32 v109, 0
    v_mov_b32 v110, 0
    v_mov_b32 v111, 0
    s_barrier
    ds_read_b128 v[16:19], v6 offset:0
    ds_read_b128 v[24:27], v6 offset:2048
    ds_read_b128 v[32:35], v6 offset:4096
    ds_read_b128 v[40:43], v6 offset:6144
    ds_read_b128 v[48:51], v6 offset:8192
    s_waitcnt lgkmcnt(3)
    v_mfma_f32_32x32x16_bf16 v[80:95], v[128:131], v[16:19], v[80:95]
    ds_read_b128 v[56:59], v6 offset:10240
    v_mfma_f32_32x32x16_bf16 v[96:111], v[132:135], v[24:27], v[96:111]
    ds_read_b128 v[64:67], v6 offset:12288
    s_waitcnt lgkmcnt(3)
    v_mfma_f32_32x32x16_bf16 v[80:95], v[136:139], v[32:35], v[80:95]
    ds_read_b128 v[72:75], v6 offset:14336
    v_mfma_f32_32x32x16_bf16 v[96:111], v[140:143], v[40:43], v[96:111]
    s_barrier
    ds_read_b128 v[16:19], v6 offset:16384
    s_waitcnt lgkmcnt(3)
    v_mfma_f32_32x32x16_bf16 v[80:95], v[144:147], v[48:51], v[80:95]
    ds_read_b128 v[24:27], v6 offset:18432
    v_mfma_f32_32x32x16_bf16 v[96:111], v[148:151], v[56:59], v[96:111]
    ds_read_b128 v[32:35], v6 offset:20480
    s_waitcnt lgkmcnt(3)
    v_mfma_f32_32x32x16_bf16 v[80:95], v[152:155], v[64:67], v[80:95]
    ds_read_b128 v[40:43], v6 offset:22528
    v_mfma_f32_32x32x16_bf16 v[96:111], v[156:159], v[72:75], v[96:111]
    ds_read_b128 v[48:51], v6 offset:24576
    s_waitcnt lgkmcnt(3)
    v_mfma_f32_32x32x16_bf16 v[80:95], v[160:163], v[16:19], v[80:95]
    ds_read_b128 v[56:59], v6 offset:26624
    v_mfma_f32_32x32x16_bf16 v[96:111], v[164:167], v[24:27], v[96:111]
    ds_read_b128 v[64:67], v6 offset:28672
    s_waitcnt lgkmcnt(3)
    v_mfma_f32_32x32x16_bf16 v[80:95], v[168:171], v[32:35], v[80:95]
    ds_read_b128 v[72:75], v6 offset:30720
    v_mfma_f32_32x32x16_bf16 v[96:111], v[172:175], v[40:43], v[96:111]
    s_barrier
    ds_read_b128 v[16:19], v6 offset:32768
    s_waitcnt lgkmcnt(3)
    v_mfma_f32_32x32x16_bf16 v[80:95], v[176:179], v[48:51], v[80:95]
    ds_read_b128 v[24:27], v6 offset:34816
    v_mfma_f32_32x32x16_bf16 v[96:111], v[180:183], v[56:59], v[96:111]
    ds_read_b128 v[32:35], v6 offset:36864
    s_waitcnt lgkmcnt(3)
    v_mfma_f32_32x32x16_bf16 v[80:95], v[184:187], v[64:67], v[80:95]
    ds_read_b128 v[40:43], v6 offset:38912
    v_mfma_f32_32x32x16_bf16 v[96:111], v[188:191], v[72:75], v[96:111]
    ds_read_b128 v[48:51], v6 offset:40960
    s_waitcnt lgkmcnt(3)
    v_mfma_f32_32x32x16_bf16 v[80:95], v[192:195], v[16:19], v[80:95]
    ds_read_b128 v[56:59], v6 offset:43008
    v_mfma_f32_32x32x16_bf16 v[96:111], v[196:199], v[24:27], v[96:111]
    ds_read_b128 v[64:67], v6 offset:45056
    s_waitcnt lgkmcnt(3)
    v_mfma_f32_32x32x16_bf16 v[80:95], v[200:203], v[32:35], v[80:95]
    ds_read_b128 v[72:75], v6 offset:47104
    v_mfma_f32_32x32x16_bf16 v[96:111], v[204:207], v[40:43], v[96:111]
    s_barrier
    ds_read_b128 v[16:19], v8 offset:0
    s_waitcnt lgkmcnt(3)
    v_mfma_f32_32x32x16_bf16 v[80:95], v[208:211], v[48:51], v[80:95]
    ds_read_b128 v[24:27], v8 offset:2048
    v_mfma_f32_32x32x16_bf16 v[96:111], v[212:215], v[56:59], v[96:111]
    ds_read_b128 v[32:35], v8 offset:4096
    s_waitcnt lgkmcnt(3)
    v_mfma_f32_32x32x16_bf16 v[80:95], v[216:219], v[64:67], v[80:95]
    ds_read_b128 v[40:43], v8 offset:6144
    v_mfma_f32_32x32x16_bf16 v[96:111], v[220:223], v[72:75], v[96:111]
    ds_read_b128 v[48:51], v8 offset:8192
    s_waitcnt lgkmcnt(3)
    v_mfma_f32_32x32x16_bf16 v[80:95], v[224:227], v[16:19], v[80:95]
    ds_read_b128 v[56:59], v8 offset:10240
    v_mfma_f32_32x32x16_bf16 v[96:111], v[228:231], v[24:27], v[96:111]
    ds_read_b128 v[64:67], v8 offset:12288
    s_waitcnt lgkmcnt(3)
    v_mfma_f32_32x32x16_bf16 v[80:95], v[232:235], v[32:35], v[80:95]
    ds_read_b128 v[72:75], v8 offset:14336
    v_mfma_f32_32x32x16_bf16 v[96:111], v[236:239], v[40:43], v[96:111]
    s_barrier
    ds_read_b128 v[16:19], v8 offset:16384
    ds_read_b64_tr_b16 v[20:21], v9 offset:16384
    ds_read_b64_tr_b16 v[22:23], v9 offset:16896
    s_waitcnt lgkmcnt(5)
    v_mfma_f32_32x32x16_bf16 v[80:95], v[240:243], v[48:51], v[80:95]
    ds_read_b128 v[24:27], v8 offset:18432
    ds_read_b64_tr_b16 v[28:29], v9 offset:18432
    ds_read_b64_tr_b16 v[30:31], v9 offset:18944
    v_mfma_f32_32x32x16_bf16 v[96:111], v[244:247], v[56:59], v[96:111]
    ds_read_b128 v[32:35], v8 offset:20480
    ds_read_b64_tr_b16 v[36:37], v9 offset:20480
    ds_read_b64_tr_b16 v[38:39], v9 offset:20992
    s_waitcnt lgkmcnt(9)
    v_mfma_f32_32x32x16_bf16 v[80:95], v[248:251], v[64:67], v[80:95]
    ds_read_b128 v[40:43], v8 offset:22528
    ds_read_b64_tr_b16 v[44:45], v9 offset:22528
    ds_read_b64_tr_b16 v[46:47], v9 offset:23040
    v_mfma_f32_32x32x16_bf16 v[96:111], v[252:255], v[72:75], v[96:111]
    ds_read_b128 v[48:51], v8 offset:24576
    ds_read_b64_tr_b16 v[52:53], v9 offset:24576
    ds_read_b64_tr_b16 v[54:55], v9 offset:25088
    s_waitcnt lgkmcnt(9)
    v_mfma_f32_32x32x16_bf16 v[80:95], v[20:23], v[16:19], v[80:95]
    ds_read_b128 v[56:59], v8 offset:26624
    ds_read_b64_tr_b16 v[60:61], v9 offset:26624
    ds_read_b64_tr_b16 v[62:63], v9 offset:27136
    v_mfma_f32_32x32x16_bf16 v[96:111], v[28:31], v[24:27], v[96:111]
    ds_read_b128 v[64:67], v8 offset:28672
    ds_read_b64_tr_b16 v[68:69], v9 offset:28672
    ds_read_b64_tr_b16 v[70:71], v9 offset:29184
    s_waitcnt lgkmcnt(9)
    v_mfma_f32_32x32x16_bf16 v[80:95], v[36:39], v[32:35], v[80:95]
    ds_read_b128 v[72:75], v8 offset:30720
    ds_read_b64_tr_b16 v[76:77], v9 offset:30720
    ds_read_b64_tr_b16 v[78:79], v9 offset:31232
    v_mfma_f32_32x32x16_bf16 v[96:111], v[44:47], v[40:43], v[96:111]
    s_barrier
    ds_read_b128 v[16:19], v6 offset:0
    ds_read_b64_tr_b16 v[20:21], v7 offset:0
    ds_read_b64_tr_b16 v[22:23], v7 offset:512
    s_waitcnt lgkmcnt(9)
    v_mfma_f32_32x32x16_bf16 v[80:95], v[52:55], v[48:51], v[80:95]
    ds_read_b128 v[24:27], v6 offset:2048
    ds_read_b64_tr_b16 v[28:29], v7 offset:2048
    ds_read_b64_tr_b16 v[30:31], v7 offset:2560
    v_mfma_f32_32x32x16_bf16 v[96:111], v[60:63], v[56:59], v[96:111]
    ds_read_b128 v[32:35], v6 offset:4096
    ds_read_b64_tr_b16 v[36:37], v7 offset:4096
    ds_read_b64_tr_b16 v[38:39], v7 offset:4608
    s_waitcnt lgkmcnt(9)
    v_mfma_f32_32x32x16_bf16 v[80:95], v[68:71], v[64:67], v[80:95]
    ds_read_b128 v[40:43], v6 offset:6144
    ds_read_b64_tr_b16 v[44:45], v7 offset:6144
    ds_read_b64_tr_b16 v[46:47], v7 offset:6656
    v_mfma_f32_32x32x16_bf16 v[96:111], v[76:79], v[72:75], v[96:111]
    ds_read_b128 v[48:51], v6 offset:8192
    ds_read_b64_tr_b16 v[52:53], v7 offset:8192
    ds_read_b64_tr_b16 v[54:55], v7 offset:8704
    s_waitcnt lgkmcnt(9)
    v_mfma_f32_32x32x16_bf16 v[80:95], v[20:23], v[16:19], v[80:95]
    ds_read_b128 v[56:59], v6 offset:10240
    ds_read_b64_tr_b16 v[60:61], v7 offset:10240
    ds_read_b64_tr_b16 v[62:63], v7 offset:10752
    v_mfma_f32_32x32x16_bf16 v[96:111], v[28:31], v[24:27], v[96:111]
    ds_read_b128 v[64:67], v6 offset:12288
    ds_read_b64_tr_b16 v[68:69], v7 offset:12288
    ds_read_b64_tr_b16 v[70:71], v7 offset:12800
    s_waitcnt lgkmcnt(9)
    v_mfma_f32_32x32x16_bf16 v[80:95], v[36:39], v[32:35], v[80:95]
    ds_read_b128 v[72:75], v6 offset:14336
    ds_read_b64_tr_b16 v[76:77], v7 offset:14336
    ds_read_b64_tr_b16 v[78:79], v7 offset:14848
    v_mfma_f32_32x32x16_bf16 v[96:111], v[44:47], v[40:43], v[96:111]
    s_barrier
    ds_read_b128 v[16:19], v6 offset:16384
    ds_read_b64_tr_b16 v[20:21], v7 offset:16384
    ds_read_b64_tr_b16 v[22:23], v7 offset:16896
    s_waitcnt lgkmcnt(9)
    v_mfma_f32_32x32x16_bf16 v[80:95], v[52:55], v[48:51], v[80:95]
    ds_read_b128 v[24:27], v6 offset:18432
    ds_read_b64_tr_b16 v[28:29], v7 offset:18432
    ds_read_b64_tr_b16 v[30:31], v7 offset:18944
    v_mfma_f32_32x32x16_bf16 v[96:111], v[60:63], v[56:59], v[96:111]
    ds_read_b128 v[32:35], v6 offset:20480
    ds_read_b64_tr_b16 v[36:37], v7 offset:20480
    ds_read_b64_tr_b16 v[38:39], v7 offset:20992
    s_waitcnt lgkmcnt(9)
    v_mfma_f32_32x32x16_bf16 v[80:95], v[68:71], v[64:67], v[80:95]
    ds_read_b128 v[40:43], v6 offset:22528
    ds_read_b64_tr_b16 v[44:45], v7 offset:22528
    ds_read_b64_tr_b16 v[46:47], v7 offset:23040
    v_mfma_f32_32x32x16_bf16 v[96:111], v[76:79], v[72:75], v[96:111]
    ds_read_b128 v[48:51], v6 offset:24576
    ds_read_b64_tr_b16 v[52:53], v7 offset:24576
    ds_read_b64_tr_b16 v[54:55], v7 offset:25088
    s_waitcnt lgkmcnt(9)
    v_mfma_f32_32x32x16_bf16 v[80:95], v[20:23], v[16:19], v[80:95]
    ds_read_b128 v[56:59], v6 offset:26624
    ds_read_b64_tr_b16 v[60:61], v7 offset:26624
    ds_read_b64_tr_b16 v[62:63], v7 offset:27136
    v_mfma_f32_32x32x16_bf16 v[96:111], v[28:31], v[24:27], v[96:111]
    ds_read_b128 v[64:67], v6 offset:28672
    ds_read_b64_tr_b16 v[68:69], v7 offset:28672
    ds_read_b64_tr_b16 v[70:71], v7 offset:29184
    s_waitcnt lgkmcnt(9)
    v_mfma_f32_32x32x16_bf16 v[80:95], v[36:39], v[32:35], v[80:95]
    ds_read_b128 v[72:75], v6 offset:30720
    ds_read_b64_tr_b16 v[76:77], v7 offset:30720
    ds_read_b64_tr_b16 v[78:79], v7 offset:31232
    v_mfma_f32_32x32x16_bf16 v[96:111], v[44:47], v[40:43], v[96:111]
    s_barrier
    ds_read_b128 v[16:19], v6 offset:32768
    ds_read_b64_tr_b16 v[20:21], v7 offset:32768
    ds_read_b64_tr_b16 v[22:23], v7 offset:33280
    s_waitcnt lgkmcnt(9)
    v_mfma_f32_32x32x16_bf16 v[80:95], v[52:55], v[48:51], v[80:95]
    ds_read_b128 v[24:27], v6 offset:34816
    ds_read_b64_tr_b16 v[28:29], v7 offset:34816
    ds_read_b64_tr_b16 v[30:31], v7 offset:35328
    v_mfma_f32_32x32x16_bf16 v[96:111], v[60:63], v[56:59], v[96:111]
    ds_read_b128 v[32:35], v6 offset:36864
    ds_read_b64_tr_b16 v[36:37], v7 offset:36864
    ds_read_b64_tr_b16 v[38:39], v7 offset:37376
    s_waitcnt lgkmcnt(9)
    v_mfma_f32_32x32x16_bf16 v[80:95], v[68:71], v[64:67], v[80:95]
    ds_read_b128 v[40:43], v6 offset:38912
    ds_read_b64_tr_b16 v[44:45], v7 offset:38912
    ds_read_b64_tr_b16 v[46:47], v7 offset:39424
    v_mfma_f32_32x32x16_bf16 v[96:111], v[76:79], v[72:75], v[96:111]
    ds_read_b128 v[48:51], v6 offset:40960
    ds_read_b64_tr_b16 v[52:53], v7 offset:40960
    ds_read_b64_tr_b16 v[54:55], v7 offset:41472
    s_waitcnt lgkmcnt(9)
    v_mfma_f32_32x32x16_bf16 v[80:95], v[20:23], v[16:19], v[80:95]
    ds_read_b128 v[56:59], v6 offset:43008
    ds_read_b64_tr_b16 v[60:61], v7 offset:43008
    ds_read_b64_tr_b16 v[62:63], v7 offset:43520
    v_mfma_f32_32x32x16_bf16 v[96:111], v[28:31], v[24:27], v[96:111]
    ds_read_b128 v[64:67], v6 offset:45056
    ds_read_b64_tr_b16 v[68:69], v7 offset:45056
    ds_read_b64_tr_b16 v[70:71], v7 offset:45568
    s_waitcnt lgkmcnt(9)
    v_mfma_f32_32x32x16_bf16 v[80:95], v[36:39], v[32:35], v[80:95]
    ds_read_b128 v[72:75], v6 offset:47104
    ds_read_b64_tr_b16 v[76:77], v7 offset:47104
    ds_read_b64_tr_b16 v[78:79], v7 offset:47616
    v_mfma_f32_32x32x16_bf16 v[96:111], v[44:47], v[40:43], v[96:111]
    s_barrier
    ds_read_b128 v[16:19], v8 offset:0
    ds_read_b64_tr_b16 v[20:21], v9 offset:0
    ds_read_b64_tr_b16 v[22:23], v9 offset:512
    s_waitcnt lgkmcnt(9)
    v_mfma_f32_32x32x16_bf16 v[80:95], v[52:55], v[48:51], v[80:95]
    ds_read_b128 v[24:27], v8 offset:2048
    ds_read_b64_tr_b16 v[28:29], v9 offset:2048
    ds_read_b64_tr_b16 v[30:31], v9 offset:2560
    v_mfma_f32_32x32x16_bf16 v[96:111], v[60:63], v[56:59], v[96:111]
    ds_read_b128 v[32:35], v8 offset:4096
    ds_read_b64_tr_b16 v[36:37], v9 offset:4096
    ds_read_b64_tr_b16 v[38:39], v9 offset:4608
    s_waitcnt lgkmcnt(9)
    v_mfma_f32_32x32x16_bf16 v[80:95], v[68:71], v[64:67], v[80:95]
    ds_read_b128 v[40:43], v8 offset:6144
    ds_read_b64_tr_b16 v[44:45], v9 offset:6144
    ds_read_b64_tr_b16 v[46:47], v9 offset:6656
    v_mfma_f32_32x32x16_bf16 v[96:111], v[76:79], v[72:75], v[96:111]
    ds_read_b128 v[48:51], v8 offset:8192
    ds_read_b64_tr_b16 v[52:53], v9 offset:8192
    ds_read_b64_tr_b16 v[54:55], v9 offset:8704
    s_waitcnt lgkmcnt(9)
    v_mfma_f32_32x32x16_bf16 v[80:95], v[20:23], v[16:19], v[80:95]
    ds_read_b128 v[56:59], v8 offset:10240
    ds_read_b64_tr_b16 v[60:61], v9 offset:10240
    ds_read_b64_tr_b16 v[62:63], v9 offset:10752
    v_mfma_f32_32x32x16_bf16 v[96:111], v[28:31], v[24:27], v[96:111]
    ds_read_b128 v[64:67], v8 offset:12288
    ds_read_b64_tr_b16 v[68:69], v9 offset:12288
    ds_read_b64_tr_b16 v[70:71], v9 offset:12800
    s_waitcnt lgkmcnt(9)
    v_mfma_f32_32x32x16_bf16 v[80:95], v[36:39], v[32:35], v[80:95]
    ds_read_b128 v[72:75], v8 offset:14336
    ds_read_b64_tr_b16 v[76:77], v9 offset:14336
    ds_read_b64_tr_b16 v[78:79], v9 offset:14848
    v_mfma_f32_32x32x16_bf16 v[96:111], v[44:47], v[40:43], v[96:111]
    s_barrier
    ds_read_b128 v[16:19], v8 offset:16384
    ds_read_b64_tr_b16 v[20:21], v9 offset:16384
    ds_read_b64_tr_b16 v[22:23], v9 offset:16896
    s_waitcnt lgkmcnt(9)
    v_mfma_f32_32x32x16_bf16 v[80:95], v[52:55], v[48:51], v[80:95]
    ds_read_b128 v[24:27], v8 offset:18432
    ds_read_b64_tr_b16 v[28:29], v9 offset:18432
    ds_read_b64_tr_b16 v[30:31], v9 offset:18944
    v_mfma_f32_32x32x16_bf16 v[96:111], v[60:63], v[56:59], v[96:111]
    ds_read_b128 v[32:35], v8 offset:20480
    ds_read_b64_tr_b16 v[36:37], v9 offset:20480
    ds_read_b64_tr_b16 v[38:39], v9 offset:20992
    s_waitcnt lgkmcnt(9)
    v_mfma_f32_32x32x16_bf16 v[80:95], v[68:71], v[64:67], v[80:95]
    ds_read_b128 v[40:43], v8 offset:22528
    ds_read_b64_tr_b16 v[44:45], v9 offset:22528
    ds_read_b64_tr_b16 v[46:47], v9 offset:23040
    v_mfma_f32_32x32x16_bf16 v[96:111], v[76:79], v[72:75], v[96:111]
    ds_read_b128 v[48:51], v8 offset:24576
    ds_read_b64_tr_b16 v[52:53], v9 offset:24576
    ds_read_b64_tr_b16 v[54:55], v9 offset:25088
    s_waitcnt lgkmcnt(9)
    v_mfma_f32_32x32x16_bf16 v[80:95], v[20:23], v[16:19], v[80:95]
    ds_read_b128 v[56:59], v8 offset:26624
    ds_read_b64_tr_b16 v[60:61], v9 offset:26624
    ds_read_b64_tr_b16 v[62:63], v9 offset:27136
    v_mfma_f32_32x32x16_bf16 v[96:111], v[28:31], v[24:27], v[96:111]
    ds_read_b128 v[64:67], v8 offset:28672
    ds_read_b64_tr_b16 v[68:69], v9 offset:28672
    ds_read_b64_tr_b16 v[70:71], v9 offset:29184
    s_waitcnt lgkmcnt(9)
    v_mfma_f32_32x32x16_bf16 v[80:95], v[36:39], v[32:35], v[80:95]
    ds_read_b128 v[72:75], v8 offset:30720
    ds_read_b64_tr_b16 v[76:77], v9 offset:30720
    ds_read_b64_tr_b16 v[78:79], v9 offset:31232
    v_mfma_f32_32x32x16_bf16 v[96:111], v[44:47], v[40:43], v[96:111]
    s_barrier
    ds_read_b128 v[16:19], v6 offset:0
    ds_read_b64_tr_b16 v[20:21], v7 offset:0
    ds_read_b64_tr_b16 v[22:23], v7 offset:512
    s_waitcnt lgkmcnt(9)
    v_mfma_f32_32x32x16_bf16 v[80:95], v[52:55], v[48:51], v[80:95]
    ds_read_b128 v[24:27], v6 offset:2048
    ds_read_b64_tr_b16 v[28:29], v7 offset:2048
    ds_read_b64_tr_b16 v[30:31], v7 offset:2560
    v_mfma_f32_32x32x16_bf16 v[96:111], v[60:63], v[56:59], v[96:111]
    ds_read_b128 v[32:35], v6 offset:4096
    ds_read_b64_tr_b16 v[36:37], v7 offset:4096
    ds_read_b64_tr_b16 v[38:39], v7 offset:4608
    s_waitcnt lgkmcnt(9)
    v_mfma_f32_32x32x16_bf16 v[80:95], v[68:71], v[64:67], v[80:95]
    ds_read_b128 v[40:43], v6 offset:6144
    ds_read_b64_tr_b16 v[44:45], v7 offset:6144
    ds_read_b64_tr_b16 v[46:47], v7 offset:6656
    v_mfma_f32_32x32x16_bf16 v[96:111], v[76:79], v[72:75], v[96:111]
    ds_read_b128 v[48:51], v6 offset:8192
    ds_read_b64_tr_b16 v[52:53], v7 offset:8192
    ds_read_b64_tr_b16 v[54:55], v7 offset:8704
    s_waitcnt lgkmcnt(9)
    v_mfma_f32_32x32x16_bf16 v[80:95], v[20:23], v[16:19], v[80:95]
    ds_read_b128 v[56:59], v6 offset:10240
    ds_read_b64_tr_b16 v[60:61], v7 offset:10240
    ds_read_b64_tr_b16 v[62:63], v7 offset:10752
    v_mfma_f32_32x32x16_bf16 v[96:111], v[28:31], v[24:27], v[96:111]
    ds_read_b128 v[64:67], v6 offset:12288
    ds_read_b64_tr_b16 v[68:69], v7 offset:12288
    ds_read_b64_tr_b16 v[70:71], v7 offset:12800
    s_waitcnt lgkmcnt(9)
    v_mfma_f32_32x32x16_bf16 v[80:95], v[36:39], v[32:35], v[80:95]
    ds_read_b128 v[72:75], v6 offset:14336
    ds_read_b64_tr_b16 v[76:77], v7 offset:14336
    ds_read_b64_tr_b16 v[78:79], v7 offset:14848
    v_mfma_f32_32x32x16_bf16 v[96:111], v[44:47], v[40:43], v[96:111]
    s_barrier
    ds_read_b128 v[16:19], v6 offset:16384
    ds_read_b64_tr_b16 v[20:21], v7 offset:16384
    ds_read_b64_tr_b16 v[22:23], v7 offset:16896
    s_waitcnt lgkmcnt(9)
    v_mfma_f32_32x32x16_bf16 v[80:95], v[52:55], v[48:51], v[80:95]
    ds_read_b128 v[24:27], v6 offset:18432
    ds_read_b64_tr_b16 v[28:29], v7 offset:18432
    ds_read_b64_tr_b16 v[30:31], v7 offset:18944
    v_mfma_f32_32x32x16_bf16 v[96:111], v[60:63], v[56:59], v[96:111]
    ds_read_b128 v[32:35], v6 offset:20480
    ds_read_b64_tr_b16 v[36:37], v7 offset:20480
    ds_read_b64_tr_b16 v[38:39], v7 offset:20992
    s_waitcnt lgkmcnt(9)
    v_mfma_f32_32x32x16_bf16 v[80:95], v[68:71], v[64:67], v[80:95]
    ds_read_b128 v[40:43], v6 offset:22528
    ds_read_b64_tr_b16 v[44:45], v7 offset:22528
    ds_read_b64_tr_b16 v[46:47], v7 offset:23040
    v_mfma_f32_32x32x16_bf16 v[96:111], v[76:79], v[72:75], v[96:111]
    ds_read_b128 v[48:51], v6 offset:24576
    ds_read_b64_tr_b16 v[52:53], v7 offset:24576
    ds_read_b64_tr_b16 v[54:55], v7 offset:25088
    s_waitcnt lgkmcnt(9)
    v_mfma_f32_32x32x16_bf16 v[80:95], v[20:23], v[16:19], v[80:95]
    ds_read_b128 v[56:59], v6 offset:26624
    ds_read_b64_tr_b16 v[60:61], v7 offset:26624
    ds_read_b64_tr_b16 v[62:63], v7 offset:27136
    v_mfma_f32_32x32x16_bf16 v[96:111], v[28:31], v[24:27], v[96:111]
    ds_read_b128 v[64:67], v6 offset:28672
    ds_read_b64_tr_b16 v[68:69], v7 offset:28672
    ds_read_b64_tr_b16 v[70:71], v7 offset:29184
    s_waitcnt lgkmcnt(9)
    v_mfma_f32_32x32x16_bf16 v[80:95], v[36:39], v[32:35], v[80:95]
    ds_read_b128 v[72:75], v6 offset:30720
    ds_read_b64_tr_b16 v[76:77], v7 offset:30720
    ds_read_b64_tr_b16 v[78:79], v7 offset:31232
    v_mfma_f32_32x32x16_bf16 v[96:111], v[44:47], v[40:43], v[96:111]
    s_barrier
    ds_read_b128 v[16:19], v6 offset:32768
    ds_read_b64_tr_b16 v[20:21], v7 offset:32768
    ds_read_b64_tr_b16 v[22:23], v7 offset:33280
    s_waitcnt lgkmcnt(9)
    v_mfma_f32_32x32x16_bf16 v[80:95], v[52:55], v[48:51], v[80:95]
    ds_read_b128 v[24:27], v6 offset:34816
    ds_read_b64_tr_b16 v[28:29], v7 offset:34816
    ds_read_b64_tr_b16 v[30:31], v7 offset:35328
    v_mfma_f32_32x32x16_bf16 v[96:111], v[60:63], v[56:59], v[96:111]
    ds_read_b128 v[32:35], v6 offset:36864
    ds_read_b64_tr_b16 v[36:37], v7 offset:36864
    ds_read_b64_tr_b16 v[38:39], v7 offset:37376
    s_waitcnt lgkmcnt(9)
    v_mfma_f32_32x32x16_bf16 v[80:95], v[68:71], v[64:67], v[80:95]
    ds_read_b128 v[40:43], v6 offset:38912
    ds_read_b64_tr_b16 v[44:45], v7 offset:38912
    ds_read_b64_tr_b16 v[46:47], v7 offset:39424
    v_mfma_f32_32x32x16_bf16 v[96:111], v[76:79], v[72:75], v[96:111]
    ds_read_b128 v[48:51], v6 offset:40960
    ds_read_b64_tr_b16 v[52:53], v7 offset:40960
    ds_read_b64_tr_b16 v[54:55], v7 offset:41472
    s_waitcnt lgkmcnt(9)
    v_mfma_f32_32x32x16_bf16 v[80:95], v[20:23], v[16:19], v[80:95]
    ds_read_b128 v[56:59], v6 offset:43008
    ds_read_b64_tr_b16 v[60:61], v7 offset:43008
    ds_read_b64_tr_b16 v[62:63], v7 offset:43520
    v_mfma_f32_32x32x16_bf16 v[96:111], v[28:31], v[24:27], v[96:111]
    ds_read_b128 v[64:67], v6 offset:45056
    ds_read_b64_tr_b16 v[68:69], v7 offset:45056
    ds_read_b64_tr_b16 v[70:71], v7 offset:45568
    s_waitcnt lgkmcnt(9)
    v_mfma_f32_32x32x16_bf16 v[80:95], v[36:39], v[32:35], v[80:95]
    ds_read_b128 v[72:75], v6 offset:47104
    ds_read_b64_tr_b16 v[76:77], v7 offset:47104
    ds_read_b64_tr_b16 v[78:79], v7 offset:47616
    v_mfma_f32_32x32x16_bf16 v[96:111], v[44:47], v[40:43], v[96:111]
    s_barrier
    ds_read_b128 v[16:19], v8 offset:0
    ds_read_b64_tr_b16 v[20:21], v9 offset:0
    ds_read_b64_tr_b16 v[22:23], v9 offset:512
    s_waitcnt lgkmcnt(9)
    v_mfma_f32_32x32x16_bf16 v[80:95], v[52:55], v[48:51], v[80:95]
    ds_read_b128 v[24:27], v8 offset:2048
    ds_read_b64_tr_b16 v[28:29], v9 offset:2048
    ds_read_b64_tr_b16 v[30:31], v9 offset:2560
    v_mfma_f32_32x32x16_bf16 v[96:111], v[60:63], v[56:59], v[96:111]
    ds_read_b128 v[32:35], v8 offset:4096
    ds_read_b64_tr_b16 v[36:37], v9 offset:4096
    ds_read_b64_tr_b16 v[38:39], v9 offset:4608
    s_waitcnt lgkmcnt(9)
    v_mfma_f32_32x32x16_bf16 v[80:95], v[68:71], v[64:67], v[80:95]
    ds_read_b128 v[40:43], v8 offset:6144
    ds_read_b64_tr_b16 v[44:45], v9 offset:6144
    ds_read_b64_tr_b16 v[46:47], v9 offset:6656
    v_mfma_f32_32x32x16_bf16 v[96:111], v[76:79], v[72:75], v[96:111]
    ds_read_b128 v[48:51], v8 offset:8192
    ds_read_b64_tr_b16 v[52:53], v9 offset:8192
    ds_read_b64_tr_b16 v[54:55], v9 offset:8704
    s_waitcnt lgkmcnt(9)
    v_mfma_f32_32x32x16_bf16 v[80:95], v[20:23], v[16:19], v[80:95]
    ds_read_b128 v[56:59], v8 offset:10240
    ds_read_b64_tr_b16 v[60:61], v9 offset:10240
    ds_read_b64_tr_b16 v[62:63], v9 offset:10752
    v_mfma_f32_32x32x16_bf16 v[96:111], v[28:31], v[24:27], v[96:111]
    ds_read_b128 v[64:67], v8 offset:12288
    ds_read_b64_tr_b16 v[68:69], v9 offset:12288
    ds_read_b64_tr_b16 v[70:71], v9 offset:12800
    s_waitcnt lgkmcnt(9)
    v_mfma_f32_32x32x16_bf16 v[80:95], v[36:39], v[32:35], v[80:95]
    ds_read_b128 v[72:75], v8 offset:14336
    ds_read_b64_tr_b16 v[76:77], v9 offset:14336
    ds_read_b64_tr_b16 v[78:79], v9 offset:14848
    v_mfma_f32_32x32x16_bf16 v[96:111], v[44:47], v[40:43], v[96:111]
    s_waitcnt lgkmcnt(6)
    v_mfma_f32_32x32x16_bf16 v[80:95], v[52:55], v[48:51], v[80:95]
    v_mfma_f32_32x32x16_bf16 v[96:111], v[60:63], v[56:59], v[96:111]
    s_waitcnt lgkmcnt(0)
    v_mfma_f32_32x32x16_bf16 v[80:95], v[68:71], v[64:67], v[80:95]
    v_mfma_f32_32x32x16_bf16 v[96:111], v[76:79], v[72:75], v[96:111]
    s_waitcnt vmcnt(0)
    v_lshlrev_b32 v16, 16, v112
    v_and_b32 v17, 0xffff0000, v112
    v_lshlrev_b32 v18, 16, v113
    v_and_b32 v19, 0xffff0000, v113
    v_lshlrev_b32 v20, 16, v114
    v_and_b32 v21, 0xffff0000, v114
    v_lshlrev_b32 v22, 16, v115
    v_and_b32 v23, 0xffff0000, v115
    v_lshlrev_b32 v24, 16, v116
    v_and_b32 v25, 0xffff0000, v116
    v_lshlrev_b32 v26, 16, v117
    v_and_b32 v27, 0xffff0000, v117
    v_lshlrev_b32 v28, 16, v118
    v_and_b32 v29, 0xffff0000, v118
    v_lshlrev_b32 v30, 16, v119
    v_and_b32 v31, 0xffff0000, v119
    v_lshlrev_b32 v10, 16, v120
    v_and_b32 v11, 0xffff0000, v120
    v_pk_add_f32 v[16:17], v[16:17], v[10:11]
    v_lshlrev_b32 v10, 16, v121
    v_and_b32 v11, 0xffff0000, v121
    v_pk_add_f32 v[18:19], v[18:19], v[10:11]
    v_lshlrev_b32 v10, 16, v122
    v_and_b32 v11, 0xffff0000, v122
    v_pk_add_f32 v[20:21], v[20:21], v[10:11]
    v_lshlrev_b32 v10, 16, v123
    v_and_b32 v11, 0xffff0000, v123
    v_pk_add_f32 v[22:23], v[22:23], v[10:11]
    v_lshlrev_b32 v10, 16, v124
    v_and_b32 v11, 0xffff0000, v124
    v_pk_add_f32 v[24:25], v[24:25], v[10:11]
    v_lshlrev_b32 v10, 16, v125
    v_and_b32 v11, 0xffff0000, v125
    v_pk_add_f32 v[26:27], v[26:27], v[10:11]
    v_lshlrev_b32 v10, 16, v126
    v_and_b32 v11, 0xffff0000, v126
    v_pk_add_f32 v[28:29], v[28:29], v[10:11]
    v_lshlrev_b32 v10, 16, v127
    v_and_b32 v11, 0xffff0000, v127
    v_pk_add_f32 v[30:31], v[30:31], v[10:11]
    v_pk_add_f32 v[16:17], v[16:17], v[80:81]
    v_pk_add_f32 v[18:19], v[18:19], v[82:83]
    v_pk_add_f32 v[20:21], v[20:21], v[84:85]
    v_pk_add_f32 v[22:23], v[22:23], v[86:87]
    v_pk_add_f32 v[24:25], v[24:25], v[88:89]
    v_pk_add_f32 v[26:27], v[26:27], v[90:91]
    v_pk_add_f32 v[28:29], v[28:29], v[92:93]
    v_pk_add_f32 v[30:31], v[30:31], v[94:95]
    v_pk_add_f32 v[16:17], v[16:17], v[96:97]
    v_pk_add_f32 v[18:19], v[18:19], v[98:99]
    v_pk_add_f32 v[20:21], v[20:21], v[100:101]
    v_pk_add_f32 v[22:23], v[22:23], v[102:103]
    v_pk_add_f32 v[24:25], v[24:25], v[104:105]
    v_pk_add_f32 v[26:27], v[26:27], v[106:107]
    v_pk_add_f32 v[28:29], v[28:29], v[108:109]
    v_pk_add_f32 v[30:31], v[30:31], v[110:111]
    v_cvt_pk_bf16_f32 v32, v16, v17
    v_cvt_pk_bf16_f32 v33, v18, v19
    v_cvt_pk_bf16_f32 v34, v20, v21
    v_cvt_pk_bf16_f32 v35, v22, v23
    v_cvt_pk_bf16_f32 v36, v24, v25
    v_cvt_pk_bf16_f32 v37, v26, v27
    v_cvt_pk_bf16_f32 v38, v28, v29
    v_cvt_pk_bf16_f32 v39, v30, v31
    buffer_store_dwordx4 v[32:35], v5, s[8:11], s36 offen
    buffer_store_dwordx4 v[36:39], v5, s[8:11], s36 offen offset:32
L_mid_end:
    s_endpgm
.section .rodata,"a"
.p2align 6
.amdhsa_kernel qkv_kernel
  .amdhsa_next_free_vgpr 128
  .amdhsa_next_free_sgpr 56
  .amdhsa_accum_offset 128
  .amdhsa_group_segment_fixed_size 0
  .amdhsa_kernarg_size 88
  .amdhsa_user_sgpr_count 2
  .amdhsa_user_sgpr_kernarg_segment_ptr 1
  .amdhsa_system_sgpr_workgroup_id_x 1
.end_amdhsa_kernel
.p2align 6
.amdhsa_kernel attn_kernel
  .amdhsa_next_free_vgpr 116
  .amdhsa_next_free_sgpr 58
  .amdhsa_accum_offset 116
  .amdhsa_group_segment_fixed_size 0
  .amdhsa_kernarg_size 88
  .amdhsa_user_sgpr_count 2
  .amdhsa_user_sgpr_kernarg_segment_ptr 1
  .amdhsa_system_sgpr_workgroup_id_x 1
.end_amdhsa_kernel
.p2align 6
.amdhsa_kernel mid_kernel
  .amdhsa_next_free_vgpr 256
  .amdhsa_next_free_sgpr 66
  .amdhsa_accum_offset 256
  .amdhsa_group_segment_fixed_size 0
  .amdhsa_kernarg_size 88
  .amdhsa_user_sgpr_count 2
  .amdhsa_user_sgpr_kernarg_segment_ptr 1
  .amdhsa_system_sgpr_workgroup_id_x 1
.end_amdhsa_kernel
```
